```python
import torch

def _softmax(x, axis=-1):
    return torch.softmax(x, dim=axis)
def _gelu(x):
    return torch.nn.functional.gelu(x, approximate="tanh")
def _silu(x):
    return torch.nn.functional.silu(x)
def _sigmoid(x):
    return torch.sigmoid(x)
def _layernorm(x, axis=-1, eps=1e-5):
    m = x.mean(dim=axis, keepdim=True)
    v = x.var(dim=axis, keepdim=True, unbiased=False)
    return (x - m) / torch.sqrt(v + eps)
def _scatter_add(tgt, idx, src, axis=0):
    return tgt.clone().index_add_(axis, idx, src)
def _segment_sum(src, seg, n):
    out = torch.zeros((n,) + src.shape[1:], dtype=src.dtype)
    return out.index_add_(0, seg, src)
def _pad(x, pw):
    flat = tuple(v for pair in reversed(pw) for v in pair)
    return torch.nn.functional.pad(x, flat)

kernel_name = 'gated_mix__grouped_kv_mqa__mixer_token_mlp__prompt'

def setup_inputs():

    _w = (lambda a: (lambda t: t.to(torch.bfloat16) if t.is_floating_point() else t)(torch.as_tensor(a)))
    def _A_setup():
        B, S, D, H = 1, 2048, 640, 32
        Dh = D // H
        return {
            "x": _w((lambda *s: torch.randn(*s, dtype=torch.bfloat16) * 0.05)(B, S, D)),
            "wq": _w((lambda *s: torch.randn(*s, dtype=torch.bfloat16) * 0.8)(D, H * Dh)),
            "wk": _w((lambda *s: torch.randn(*s, dtype=torch.bfloat16) * 0.8)(D, Dh)),
            "wv": _w((lambda *s: torch.randn(*s, dtype=torch.bfloat16) * 0.05)(D, Dh)),
            "wo": _w((lambda *s: torch.randn(*s, dtype=torch.bfloat16) * 0.05)(H * Dh, D)),
        }
    _A_in = _A_setup()

    def _B_setup():
        B, S, D, F = 1, 2048, 640, 1536
        return {
            "x": _w((lambda *s: torch.randn(*s, dtype=torch.bfloat16) * 0.05)(B, S, D)),
            "w1": _w((lambda *s: torch.randn(*s, dtype=torch.bfloat16) * 0.2)(S, F) * (S ** -0.5)),
            "b1": _w((lambda *s: torch.randn(*s, dtype=torch.bfloat16) * 3.2)(F) * 0.02),
            "w2": _w((lambda *s: torch.randn(*s, dtype=torch.bfloat16) * 0.05)(F, S) * (F ** -0.5)),
            "b2": _w((lambda *s: torch.randn(*s, dtype=torch.bfloat16) * 0.1)(S) * 0.02),
        }
    _B_in = _B_setup()

    return {
        "A_x": _A_in["x"],
        "A_wq": _A_in["wq"],
        "A_wk": _A_in["wk"],
        "A_wv": _A_in["wv"],
        "A_wo": _A_in["wo"],
        "B_x": _B_in["x"],
        "B_w1": _B_in["w1"],
        "B_b1": _B_in["b1"],
        "B_w2": _B_in["w2"],
        "B_b2": _B_in["b2"],
        "gate_w": _w((lambda *s: torch.randn(*s, dtype=torch.bfloat16) * 0.05)(640) * 16.0),
    }

def reference(A_x, A_wq, A_wk, A_wv, A_wo, B_x, B_w1, B_b1, B_w2, B_b2, gate_w):
    def _A_ref(x, wq, wk, wv, wo):
        B, S, D = x.shape
        H = 32
        Dh = D // H
        q = (lambda x, *d: x.permute(*d))((x @ wq).reshape(B, S, H, Dh), 0, 2, 1, 3)
        k = x @ wk
        v = x @ wv
        scores = torch.einsum("bhqd,bkd->bhqk", q, k) * (Dh ** -0.5)
        p = _softmax(scores, axis=-1)
        o = torch.einsum("bhqk,bkd->bhqd", p, v)
        return (lambda x, *d: x.permute(*d))(o, 0, 2, 1, 3).reshape(B, S, H * Dh) @ wo

    def _B_ref(x, w1, b1, w2, b2):
        B, S, D = x.shape
        h = _layernorm(x, axis=-1)
        u = torch.einsum("bsd,sf->bdf", h, w1) + b1
        u = _gelu(u)
        y = torch.einsum("bdf,fs->bds", u, w2) + b2
        return (lambda x, *d: x.permute(*d))(y, 0, 2, 1)

    x = A_x
    g = _sigmoid((x * gate_w).sum(-1, keepdims=True))
    a = _A_ref(x, A_wq, A_wk, A_wv, A_wo)
    b = _B_ref(x, B_w1, B_b1, B_w2, B_b2)
    return g * a + (1 - g) * b
```

```asm
; @launch kernel=prep_kernel grid=(640,1,1) block=(256,1,1) lds=65536
; @launch kernel=mid_kernel grid=(496,1,1) block=(512,1,1) lds=81920
; @launch kernel=final_kernel grid=(256,1,1) block=(384,1,1) lds=94208
.amdgcn_target "amdgcn-amd-amdhsa--gfx950"
    .text
    .globl prep_kernel
    .p2align 8
    .type prep_kernel,@function
prep_kernel:
    s_load_dwordx2 s[4:5], s[0:1], 0
    s_load_dwordx2 s[6:7], s[0:1], 8
    s_load_dwordx4 s[8:11], s[0:1], 16
    s_load_dwordx2 s[12:13], s[0:1], 80
    s_load_dwordx2 s[14:15], s[0:1], 104
    s_cmp_ge_u32 s2, 640
    s_cbranch_scc1 P_end
    v_lshrrev_b32 v1, 6, v0
    v_and_b32 v0, 63, v0
    s_nop 0
    v_readfirstlane_b32 s3, v1
    s_waitcnt lgkmcnt(0)
    s_mov_b32 s16, s4
    s_and_b32 s17, s5, 0xffff
    s_mov_b32 s18, 2621440
    s_mov_b32 s19, 0x00020000
    s_mov_b32 s20, s6
    s_and_b32 s21, s7, 0xffff
    s_mov_b32 s22, 819200
    s_mov_b32 s23, 0x00020000
    s_mov_b32 s24, s14
    s_and_b32 s25, s15, 0xffff
    s_mov_b32 s26, 10027008
    s_mov_b32 s27, 0x00020000
    s_mov_b32 s36, s12
    s_and_b32 s37, s13, 0xffff
    s_mov_b32 s38, 1280
    s_mov_b32 s39, 0x00020000
    s_cmp_ge_u32 s2, 384
    s_cbranch_scc1 P_stats
    s_lshr_b32 s40, s3, 1
    s_and_b32 s41, s3, 1
    v_and_b32 v2, 31, v0
    v_lshrrev_b32 v3, 5, v0
    v_mov_b32 v48, 0
    v_mov_b32 v49, 0
    v_mov_b32 v50, 0
    v_mov_b32 v51, 0
    v_mov_b32 v52, 0
    v_mov_b32 v53, 0
    v_mov_b32 v54, 0
    v_mov_b32 v55, 0
    v_mov_b32 v56, 0
    v_mov_b32 v57, 0
    v_mov_b32 v58, 0
    v_mov_b32 v59, 0
    v_mov_b32 v60, 0
    v_mov_b32 v61, 0
    v_mov_b32 v62, 0
    v_mov_b32 v63, 0
    s_cmp_ge_u32 s2, 320
    s_cbranch_scc1 P_kv
    s_lshr_b32 s44, s2, 3
    s_mul_hi_u32 s42, s44, 0x1999999A
    s_mul_i32 s43, s42, 10
    s_sub_u32 s43, s44, s43
    s_lshl_b32 s42, s42, 3
    s_and_b32 s44, s2, 7
    s_add_u32 s42, s42, s44
    s_lshl_b32 s44, s43, 7
    s_mul_i32 s45, s42, 81920
    s_and_b32 s73, s3, 1
    s_lshl_b32 s70, s3, 12
    s_cmp_ge_u32 s3, 2
    s_cbranch_scc1 dsA_1
    s_mov_b32 s56, s20
    s_mov_b32 s57, s21
    s_mov_b32 s58, s22
    s_mov_b32 s59, s23
    s_mul_i32 s46, s73, 40960
    s_add_u32 s60, s44, s46
    s_mov_b32 s61, 81920
    s_mov_b32 s62, 0
    s_mov_b32 s63, 10240
    s_mov_b32 s64, 20480
    s_mov_b32 s65, 30720
    v_lshrrev_b32 v20, 3, v0
    v_mul_u32_u24 v20, 1280, v20
    v_bfe_u32 v1, v0, 4, 1
    v_lshlrev_b32 v1, 2, v1
    v_and_b32 v21, 7, v0
    v_xor_b32 v1, v1, v21
    v_lshl_add_u32 v20, v1, 4, v20
    v_mov_b32 v21, v20
    s_branch dsB_2
dsA_1:
    s_mov_b32 s56, s16
    s_mov_b32 s57, s17
    s_mov_b32 s58, s18
    s_mov_b32 s59, s19
    s_mul_i32 s46, s73, 40960
    s_add_u32 s60, s45, s46
    s_mov_b32 s61, 128
    s_mov_b32 s62, 0
    s_mov_b32 s63, 10240
    s_mov_b32 s64, 20480
    s_mov_b32 s65, 30720
    v_lshrrev_b32 v1, 4, v0
    v_add_u32 v1, 0, v1
    v_and_b32 v20, 7, v0
    v_xor_b32 v1, v1, v20
    v_lshrrev_b32 v20, 3, v0
    v_mul_u32_u24 v20, 1280, v20
    v_lshl_add_u32 v20, v1, 4, v20
    v_lshrrev_b32 v1, 4, v0
    v_add_u32 v1, 4, v1
    v_and_b32 v21, 7, v0
    v_xor_b32 v1, v1, v21
    v_lshrrev_b32 v21, 3, v0
    v_mul_u32_u24 v21, 1280, v21
    v_lshl_add_u32 v21, v1, 4, v21
dsB_2:
    s_lshl_b32 s46, s40, 12
    v_bfe_u32 v24, v0, 5, 1
    v_lshlrev_b32 v24, 3, v24
    v_bfe_u32 v25, v0, 2, 2
    v_add_u32 v24, v24, v25
    v_bfe_u32 v25, v0, 4, 1
    v_lshlrev_b32 v25, 1, v25
    v_bfe_u32 v26, v0, 1, 1
    v_add_u32 v25, v25, v26
    s_lshl_b32 s47, s40, 2
    v_add_u32 v25, s47, v25
    v_bfe_u32 v26, v24, 1, 1
    v_lshlrev_b32 v26, 2, v26
    v_xor_b32 v25, v25, v26
    v_lshlrev_b32 v24, 7, v24
    v_lshl_add_u32 v24, v25, 4, v24
    v_and_b32 v26, 1, v0
    v_lshl_add_u32 v24, v26, 3, v24
    s_lshl_b32 s46, s41, 12
    s_add_u32 s46, s46, 8192
    v_and_b32 v33, 31, v0
    v_lshrrev_b32 v34, 5, v0
    v_bfe_u32 v35, v0, 1, 3
    v_xor_b32 v34, v34, v35
    v_lshlrev_b32 v34, 4, v34
    v_lshl_add_u32 v32, v33, 7, v34
    v_add_u32 v32, s46, v32
    v_xor_b32 v33, 32, v32
    v_xor_b32 v34, 64, v32
    v_xor_b32 v35, 96, v32
    s_mov_b32 s74, 0
    s_mov_b32 s75, 65536
    s_mov_b32 s90, 0
    s_mov_b32 s91, 0
    s_mov_b32 s92, 7
    s_add_u32 s71, s70, s74
    s_mov_b32 m0, s71
    s_add_u32 s72, s60, s62
    buffer_load_dwordx4 v20, s[56:59], s72 offen lds
    s_add_u32 s71, s70, s74
    s_add_u32 s71, s71, 1024
    s_mov_b32 m0, s71
    s_add_u32 s72, s60, s63
    buffer_load_dwordx4 v21, s[56:59], s72 offen lds
    s_add_u32 s71, s70, s74
    s_add_u32 s71, s71, 2048
    s_mov_b32 m0, s71
    s_add_u32 s72, s60, s64
    buffer_load_dwordx4 v20, s[56:59], s72 offen lds
    s_add_u32 s71, s70, s74
    s_add_u32 s71, s71, 3072
    s_mov_b32 m0, s71
    s_add_u32 s72, s60, s65
    buffer_load_dwordx4 v21, s[56:59], s72 offen lds
    s_add_u32 s60, s60, s61
    s_add_u32 s74, s74, 16384
    s_cmp_eq_u32 s74, s75
    s_cselect_b32 s74, 0, s74
    s_add_u32 s71, s70, s74
    s_mov_b32 m0, s71
    s_add_u32 s72, s60, s62
    buffer_load_dwordx4 v20, s[56:59], s72 offen lds
    s_add_u32 s71, s70, s74
    s_add_u32 s71, s71, 1024
    s_mov_b32 m0, s71
    s_add_u32 s72, s60, s63
    buffer_load_dwordx4 v21, s[56:59], s72 offen lds
    s_add_u32 s71, s70, s74
    s_add_u32 s71, s71, 2048
    s_mov_b32 m0, s71
    s_add_u32 s72, s60, s64
    buffer_load_dwordx4 v20, s[56:59], s72 offen lds
    s_add_u32 s71, s70, s74
    s_add_u32 s71, s71, 3072
    s_mov_b32 m0, s71
    s_add_u32 s72, s60, s65
    buffer_load_dwordx4 v21, s[56:59], s72 offen lds
    s_add_u32 s60, s60, s61
    s_add_u32 s74, s74, 16384
    s_cmp_eq_u32 s74, s75
    s_cselect_b32 s74, 0, s74
    s_add_u32 s71, s70, s74
    s_mov_b32 m0, s71
    s_add_u32 s72, s60, s62
    buffer_load_dwordx4 v20, s[56:59], s72 offen lds
    s_add_u32 s71, s70, s74
    s_add_u32 s71, s71, 1024
    s_mov_b32 m0, s71
    s_add_u32 s72, s60, s63
    buffer_load_dwordx4 v21, s[56:59], s72 offen lds
    s_add_u32 s71, s70, s74
    s_add_u32 s71, s71, 2048
    s_mov_b32 m0, s71
    s_add_u32 s72, s60, s64
    buffer_load_dwordx4 v20, s[56:59], s72 offen lds
    s_add_u32 s71, s70, s74
    s_add_u32 s71, s71, 3072
    s_mov_b32 m0, s71
    s_add_u32 s72, s60, s65
    buffer_load_dwordx4 v21, s[56:59], s72 offen lds
    s_add_u32 s60, s60, s61
    s_add_u32 s74, s74, 16384
    s_cmp_eq_u32 s74, s75
    s_cselect_b32 s74, 0, s74
    s_waitcnt lgkmcnt(0)
    s_cmp_lt_u32 s91, s92
    s_cbranch_scc0 gn_3
    s_waitcnt vmcnt(8)
    s_barrier
    v_add_u32 v40, s90, v24
    v_add_u32 v41, s90, v32
    v_add_u32 v42, s90, v33
    v_add_u32 v43, s90, v34
    v_add_u32 v44, s90, v35
    ds_read_b64_tr_b16 v[80:81], v40 offset:0
    ds_read_b64_tr_b16 v[82:83], v40 offset:512
    ds_read_b128 v[84:87], v41 offset:0
    ds_read_b64_tr_b16 v[88:89], v40 offset:2048
    ds_read_b64_tr_b16 v[90:91], v40 offset:2560
    ds_read_b128 v[92:95], v42 offset:0
    ds_read_b64_tr_b16 v[96:97], v40 offset:4096
    ds_read_b64_tr_b16 v[98:99], v40 offset:4608
    ds_read_b128 v[100:103], v43 offset:0
    ds_read_b64_tr_b16 v[104:105], v40 offset:6144
    ds_read_b64_tr_b16 v[106:107], v40 offset:6656
    ds_read_b128 v[108:111], v44 offset:0
    s_add_u32 s90, s90, 16384
    s_cmp_eq_u32 s90, s75
    s_cselect_b32 s90, 0, s90
    s_add_u32 s71, s70, s74
    s_mov_b32 m0, s71
    s_add_u32 s72, s60, s62
    buffer_load_dwordx4 v20, s[56:59], s72 offen lds
    s_add_u32 s71, s70, s74
    s_add_u32 s71, s71, 1024
    s_mov_b32 m0, s71
    s_add_u32 s72, s60, s63
    buffer_load_dwordx4 v21, s[56:59], s72 offen lds
    s_add_u32 s71, s70, s74
    s_add_u32 s71, s71, 2048
    s_mov_b32 m0, s71
    s_add_u32 s72, s60, s64
    buffer_load_dwordx4 v20, s[56:59], s72 offen lds
    s_add_u32 s71, s70, s74
    s_add_u32 s71, s71, 3072
    s_mov_b32 m0, s71
    s_add_u32 s72, s60, s65
    buffer_load_dwordx4 v21, s[56:59], s72 offen lds
    s_add_u32 s60, s60, s61
    s_add_u32 s74, s74, 16384
    s_cmp_eq_u32 s74, s75
    s_cselect_b32 s74, 0, s74
    s_branch gg_4
gn_3:
    s_waitcnt vmcnt(0)
    s_barrier
    v_add_u32 v40, s90, v24
    v_add_u32 v41, s90, v32
    v_add_u32 v42, s90, v33
    v_add_u32 v43, s90, v34
    v_add_u32 v44, s90, v35
    ds_read_b64_tr_b16 v[80:81], v40 offset:0
    ds_read_b64_tr_b16 v[82:83], v40 offset:512
    ds_read_b128 v[84:87], v41 offset:0
    ds_read_b64_tr_b16 v[88:89], v40 offset:2048
    ds_read_b64_tr_b16 v[90:91], v40 offset:2560
    ds_read_b128 v[92:95], v42 offset:0
    ds_read_b64_tr_b16 v[96:97], v40 offset:4096
    ds_read_b64_tr_b16 v[98:99], v40 offset:4608
    ds_read_b128 v[100:103], v43 offset:0
    ds_read_b64_tr_b16 v[104:105], v40 offset:6144
    ds_read_b64_tr_b16 v[106:107], v40 offset:6656
    ds_read_b128 v[108:111], v44 offset:0
    s_add_u32 s90, s90, 16384
    s_cmp_eq_u32 s90, s75
    s_cselect_b32 s90, 0, s90
gg_4:
    s_add_u32 s91, s91, 1
gl_5:
    s_waitcnt lgkmcnt(0)
    s_cmp_lt_u32 s91, s92
    s_cbranch_scc0 gn_6
    s_waitcnt vmcnt(8)
    s_barrier
    v_add_u32 v40, s90, v24
    v_add_u32 v41, s90, v32
    v_add_u32 v42, s90, v33
    v_add_u32 v43, s90, v34
    v_add_u32 v44, s90, v35
    v_mfma_f32_32x32x16_bf16 v[48:63], v[80:83], v[84:87], v[48:63]
    ds_read_b64_tr_b16 v[112:113], v40 offset:0
    ds_read_b64_tr_b16 v[114:115], v40 offset:512
    ds_read_b128 v[116:119], v41 offset:0
    v_mfma_f32_32x32x16_bf16 v[48:63], v[88:91], v[92:95], v[48:63]
    ds_read_b64_tr_b16 v[120:121], v40 offset:2048
    ds_read_b64_tr_b16 v[122:123], v40 offset:2560
    ds_read_b128 v[124:127], v42 offset:0
    v_mfma_f32_32x32x16_bf16 v[48:63], v[96:99], v[100:103], v[48:63]
    ds_read_b64_tr_b16 v[128:129], v40 offset:4096
    ds_read_b64_tr_b16 v[130:131], v40 offset:4608
    ds_read_b128 v[132:135], v43 offset:0
    v_mfma_f32_32x32x16_bf16 v[48:63], v[104:107], v[108:111], v[48:63]
    ds_read_b64_tr_b16 v[136:137], v40 offset:6144
    ds_read_b64_tr_b16 v[138:139], v40 offset:6656
    ds_read_b128 v[140:143], v44 offset:0
    s_add_u32 s90, s90, 16384
    s_cmp_eq_u32 s90, s75
    s_cselect_b32 s90, 0, s90
    s_add_u32 s71, s70, s74
    s_mov_b32 m0, s71
    s_add_u32 s72, s60, s62
    buffer_load_dwordx4 v20, s[56:59], s72 offen lds
    s_add_u32 s71, s70, s74
    s_add_u32 s71, s71, 1024
    s_mov_b32 m0, s71
    s_add_u32 s72, s60, s63
    buffer_load_dwordx4 v21, s[56:59], s72 offen lds
    s_add_u32 s71, s70, s74
    s_add_u32 s71, s71, 2048
    s_mov_b32 m0, s71
    s_add_u32 s72, s60, s64
    buffer_load_dwordx4 v20, s[56:59], s72 offen lds
    s_add_u32 s71, s70, s74
    s_add_u32 s71, s71, 3072
    s_mov_b32 m0, s71
    s_add_u32 s72, s60, s65
    buffer_load_dwordx4 v21, s[56:59], s72 offen lds
    s_add_u32 s60, s60, s61
    s_add_u32 s74, s74, 16384
    s_cmp_eq_u32 s74, s75
    s_cselect_b32 s74, 0, s74
    s_branch gg_7
gn_6:
    s_waitcnt vmcnt(0)
    s_barrier
    v_add_u32 v40, s90, v24
    v_add_u32 v41, s90, v32
    v_add_u32 v42, s90, v33
    v_add_u32 v43, s90, v34
    v_add_u32 v44, s90, v35
    v_mfma_f32_32x32x16_bf16 v[48:63], v[80:83], v[84:87], v[48:63]
    ds_read_b64_tr_b16 v[112:113], v40 offset:0
    ds_read_b64_tr_b16 v[114:115], v40 offset:512
    ds_read_b128 v[116:119], v41 offset:0
    v_mfma_f32_32x32x16_bf16 v[48:63], v[88:91], v[92:95], v[48:63]
    ds_read_b64_tr_b16 v[120:121], v40 offset:2048
    ds_read_b64_tr_b16 v[122:123], v40 offset:2560
    ds_read_b128 v[124:127], v42 offset:0
    v_mfma_f32_32x32x16_bf16 v[48:63], v[96:99], v[100:103], v[48:63]
    ds_read_b64_tr_b16 v[128:129], v40 offset:4096
    ds_read_b64_tr_b16 v[130:131], v40 offset:4608
    ds_read_b128 v[132:135], v43 offset:0
    v_mfma_f32_32x32x16_bf16 v[48:63], v[104:107], v[108:111], v[48:63]
    ds_read_b64_tr_b16 v[136:137], v40 offset:6144
    ds_read_b64_tr_b16 v[138:139], v40 offset:6656
    ds_read_b128 v[140:143], v44 offset:0
    s_add_u32 s90, s90, 16384
    s_cmp_eq_u32 s90, s75
    s_cselect_b32 s90, 0, s90
gg_7:
    s_add_u32 s91, s91, 1
    s_waitcnt lgkmcnt(0)
    s_cmp_lt_u32 s91, s92
    s_cbranch_scc0 gn_8
    s_waitcnt vmcnt(8)
    s_barrier
    v_add_u32 v40, s90, v24
    v_add_u32 v41, s90, v32
    v_add_u32 v42, s90, v33
    v_add_u32 v43, s90, v34
    v_add_u32 v44, s90, v35
    v_mfma_f32_32x32x16_bf16 v[48:63], v[112:115], v[116:119], v[48:63]
    ds_read_b64_tr_b16 v[80:81], v40 offset:0
    ds_read_b64_tr_b16 v[82:83], v40 offset:512
    ds_read_b128 v[84:87], v41 offset:0
    v_mfma_f32_32x32x16_bf16 v[48:63], v[120:123], v[124:127], v[48:63]
    ds_read_b64_tr_b16 v[88:89], v40 offset:2048
    ds_read_b64_tr_b16 v[90:91], v40 offset:2560
    ds_read_b128 v[92:95], v42 offset:0
    v_mfma_f32_32x32x16_bf16 v[48:63], v[128:131], v[132:135], v[48:63]
    ds_read_b64_tr_b16 v[96:97], v40 offset:4096
    ds_read_b64_tr_b16 v[98:99], v40 offset:4608
    ds_read_b128 v[100:103], v43 offset:0
    v_mfma_f32_32x32x16_bf16 v[48:63], v[136:139], v[140:143], v[48:63]
    ds_read_b64_tr_b16 v[104:105], v40 offset:6144
    ds_read_b64_tr_b16 v[106:107], v40 offset:6656
    ds_read_b128 v[108:111], v44 offset:0
    s_add_u32 s90, s90, 16384
    s_cmp_eq_u32 s90, s75
    s_cselect_b32 s90, 0, s90
    s_add_u32 s71, s70, s74
    s_mov_b32 m0, s71
    s_add_u32 s72, s60, s62
    buffer_load_dwordx4 v20, s[56:59], s72 offen lds
    s_add_u32 s71, s70, s74
    s_add_u32 s71, s71, 1024
    s_mov_b32 m0, s71
    s_add_u32 s72, s60, s63
    buffer_load_dwordx4 v21, s[56:59], s72 offen lds
    s_add_u32 s71, s70, s74
    s_add_u32 s71, s71, 2048
    s_mov_b32 m0, s71
    s_add_u32 s72, s60, s64
    buffer_load_dwordx4 v20, s[56:59], s72 offen lds
    s_add_u32 s71, s70, s74
    s_add_u32 s71, s71, 3072
    s_mov_b32 m0, s71
    s_add_u32 s72, s60, s65
    buffer_load_dwordx4 v21, s[56:59], s72 offen lds
    s_add_u32 s60, s60, s61
    s_add_u32 s74, s74, 16384
    s_cmp_eq_u32 s74, s75
    s_cselect_b32 s74, 0, s74
    s_branch gg_9
gn_8:
    s_waitcnt vmcnt(0)
    s_barrier
    v_add_u32 v40, s90, v24
    v_add_u32 v41, s90, v32
    v_add_u32 v42, s90, v33
    v_add_u32 v43, s90, v34
    v_add_u32 v44, s90, v35
    v_mfma_f32_32x32x16_bf16 v[48:63], v[112:115], v[116:119], v[48:63]
    ds_read_b64_tr_b16 v[80:81], v40 offset:0
    ds_read_b64_tr_b16 v[82:83], v40 offset:512
    ds_read_b128 v[84:87], v41 offset:0
    v_mfma_f32_32x32x16_bf16 v[48:63], v[120:123], v[124:127], v[48:63]
    ds_read_b64_tr_b16 v[88:89], v40 offset:2048
    ds_read_b64_tr_b16 v[90:91], v40 offset:2560
    ds_read_b128 v[92:95], v42 offset:0
    v_mfma_f32_32x32x16_bf16 v[48:63], v[128:131], v[132:135], v[48:63]
    ds_read_b64_tr_b16 v[96:97], v40 offset:4096
    ds_read_b64_tr_b16 v[98:99], v40 offset:4608
    ds_read_b128 v[100:103], v43 offset:0
    v_mfma_f32_32x32x16_bf16 v[48:63], v[136:139], v[140:143], v[48:63]
    ds_read_b64_tr_b16 v[104:105], v40 offset:6144
    ds_read_b64_tr_b16 v[106:107], v40 offset:6656
    ds_read_b128 v[108:111], v44 offset:0
    s_add_u32 s90, s90, 16384
    s_cmp_eq_u32 s90, s75
    s_cselect_b32 s90, 0, s90
gg_9:
    s_add_u32 s91, s91, 1
    s_cmp_lt_u32 s91, 9
    s_cbranch_scc1 gl_5
    s_waitcnt lgkmcnt(0)
    s_cmp_lt_u32 s91, s92
    s_cbranch_scc0 gn_10
    s_waitcnt vmcnt(8)
    s_barrier
    v_add_u32 v40, s90, v24
    v_add_u32 v41, s90, v32
    v_add_u32 v42, s90, v33
    v_add_u32 v43, s90, v34
    v_add_u32 v44, s90, v35
    v_mfma_f32_32x32x16_bf16 v[48:63], v[80:83], v[84:87], v[48:63]
    ds_read_b64_tr_b16 v[112:113], v40 offset:0
    ds_read_b64_tr_b16 v[114:115], v40 offset:512
    ds_read_b128 v[116:119], v41 offset:0
    v_mfma_f32_32x32x16_bf16 v[48:63], v[88:91], v[92:95], v[48:63]
    ds_read_b64_tr_b16 v[120:121], v40 offset:2048
    ds_read_b64_tr_b16 v[122:123], v40 offset:2560
    ds_read_b128 v[124:127], v42 offset:0
    v_mfma_f32_32x32x16_bf16 v[48:63], v[96:99], v[100:103], v[48:63]
    ds_read_b64_tr_b16 v[128:129], v40 offset:4096
    ds_read_b64_tr_b16 v[130:131], v40 offset:4608
    ds_read_b128 v[132:135], v43 offset:0
    v_mfma_f32_32x32x16_bf16 v[48:63], v[104:107], v[108:111], v[48:63]
    ds_read_b64_tr_b16 v[136:137], v40 offset:6144
    ds_read_b64_tr_b16 v[138:139], v40 offset:6656
    ds_read_b128 v[140:143], v44 offset:0
    s_add_u32 s90, s90, 16384
    s_cmp_eq_u32 s90, s75
    s_cselect_b32 s90, 0, s90
    s_add_u32 s71, s70, s74
    s_mov_b32 m0, s71
    s_add_u32 s72, s60, s62
    buffer_load_dwordx4 v20, s[56:59], s72 offen lds
    s_add_u32 s71, s70, s74
    s_add_u32 s71, s71, 1024
    s_mov_b32 m0, s71
    s_add_u32 s72, s60, s63
    buffer_load_dwordx4 v21, s[56:59], s72 offen lds
    s_add_u32 s71, s70, s74
    s_add_u32 s71, s71, 2048
    s_mov_b32 m0, s71
    s_add_u32 s72, s60, s64
    buffer_load_dwordx4 v20, s[56:59], s72 offen lds
    s_add_u32 s71, s70, s74
    s_add_u32 s71, s71, 3072
    s_mov_b32 m0, s71
    s_add_u32 s72, s60, s65
    buffer_load_dwordx4 v21, s[56:59], s72 offen lds
    s_add_u32 s60, s60, s61
    s_add_u32 s74, s74, 16384
    s_cmp_eq_u32 s74, s75
    s_cselect_b32 s74, 0, s74
    s_branch gg_11
gn_10:
    s_waitcnt vmcnt(0)
    s_barrier
    v_add_u32 v40, s90, v24
    v_add_u32 v41, s90, v32
    v_add_u32 v42, s90, v33
    v_add_u32 v43, s90, v34
    v_add_u32 v44, s90, v35
    v_mfma_f32_32x32x16_bf16 v[48:63], v[80:83], v[84:87], v[48:63]
    ds_read_b64_tr_b16 v[112:113], v40 offset:0
    ds_read_b64_tr_b16 v[114:115], v40 offset:512
    ds_read_b128 v[116:119], v41 offset:0
    v_mfma_f32_32x32x16_bf16 v[48:63], v[88:91], v[92:95], v[48:63]
    ds_read_b64_tr_b16 v[120:121], v40 offset:2048
    ds_read_b64_tr_b16 v[122:123], v40 offset:2560
    ds_read_b128 v[124:127], v42 offset:0
    v_mfma_f32_32x32x16_bf16 v[48:63], v[96:99], v[100:103], v[48:63]
    ds_read_b64_tr_b16 v[128:129], v40 offset:4096
    ds_read_b64_tr_b16 v[130:131], v40 offset:4608
    ds_read_b128 v[132:135], v43 offset:0
    v_mfma_f32_32x32x16_bf16 v[48:63], v[104:107], v[108:111], v[48:63]
    ds_read_b64_tr_b16 v[136:137], v40 offset:6144
    ds_read_b64_tr_b16 v[138:139], v40 offset:6656
    ds_read_b128 v[140:143], v44 offset:0
    s_add_u32 s90, s90, 16384
    s_cmp_eq_u32 s90, s75
    s_cselect_b32 s90, 0, s90
gg_11:
    s_add_u32 s91, s91, 1
    s_waitcnt lgkmcnt(0)
    v_mfma_f32_32x32x16_bf16 v[48:63], v[112:115], v[116:119], v[48:63]
    v_mfma_f32_32x32x16_bf16 v[48:63], v[120:123], v[124:127], v[48:63]
    v_mfma_f32_32x32x16_bf16 v[48:63], v[128:131], v[132:135], v[48:63]
    v_mfma_f32_32x32x16_bf16 v[48:63], v[136:139], v[140:143], v[48:63]
    s_nop 15
    s_mov_b32 s46, 1051011932
    v_mul_f32 v48, s46, v48
    v_mul_f32 v49, s46, v49
    v_mul_f32 v50, s46, v50
    v_mul_f32 v51, s46, v51
    v_mul_f32 v52, s46, v52
    v_mul_f32 v53, s46, v53
    v_mul_f32 v54, s46, v54
    v_mul_f32 v55, s46, v55
    v_mul_f32 v56, s46, v56
    v_mul_f32 v57, s46, v57
    v_mul_f32 v58, s46, v58
    v_mul_f32 v59, s46, v59
    v_mul_f32 v60, s46, v60
    v_mul_f32 v61, s46, v61
    v_mul_f32 v62, s46, v62
    v_mul_f32 v63, s46, v63
    v_cvt_pk_bf16_f32 v64, v48, v49
    v_cvt_pk_bf16_f32 v65, v50, v51
    v_cvt_pk_bf16_f32 v66, v52, v53
    v_cvt_pk_bf16_f32 v67, v54, v55
    v_cvt_pk_bf16_f32 v68, v56, v57
    v_cvt_pk_bf16_f32 v69, v58, v59
    v_cvt_pk_bf16_f32 v70, v60, v61
    v_cvt_pk_bf16_f32 v71, v62, v63
    s_lshl_b32 s46, s42, 6
    s_lshl_b32 s47, s41, 5
    s_add_u32 s46, s46, s47
    v_add_u32 v4, s46, v2
    v_mul_u32_u24 v4, 1280, v4
    v_lshl_add_u32 v4, v3, 3, v4
    s_lshl_b32 s47, s40, 6
    s_add_u32 s46, s44, s47
    s_add_u32 s46, s46, 0
    buffer_store_dwordx2 v[64:65], v4, s[24:27], s46 offen offset:0
    buffer_store_dwordx2 v[66:67], v4, s[24:27], s46 offen offset:16
    buffer_store_dwordx2 v[68:69], v4, s[24:27], s46 offen offset:32
    buffer_store_dwordx2 v[70:71], v4, s[24:27], s46 offen offset:48
    s_branch P_end
P_kv:
    s_sub_u32 s42, s2, 320
    s_lshr_b32 s43, s42, 5
    s_and_b32 s42, s42, 31
    s_cmp_eq_u32 s43, 0
    s_cselect_b32 s28, s8, s10
    s_cselect_b32 s29, s9, s11
    s_and_b32 s29, s29, 0xffff
    s_mov_b32 s30, 25600
    s_mov_b32 s31, 0x00020000
    s_mul_i32 s45, s42, 81920
    s_and_b32 s73, s3, 1
    s_lshl_b32 s70, s3, 12
    s_cmp_ge_u32 s3, 2
    s_cbranch_scc1 kvA_12
    v_lshlrev_b32 v20, 4, v0
    s_mul_i32 s46, s3, 12800
    s_add_u32 s47, s46, 36864
    s_mov_b32 m0, s47
    s_nop 0
    buffer_load_dwordx4 v20, s[28:31], s46 offen lds
    s_add_u32 s46, s46, 1024
    s_add_u32 s47, s47, 1024
    s_mov_b32 m0, s47
    s_nop 0
    buffer_load_dwordx4 v20, s[28:31], s46 offen lds
    s_add_u32 s46, s46, 1024
    s_add_u32 s47, s47, 1024
    s_mov_b32 m0, s47
    s_nop 0
    buffer_load_dwordx4 v20, s[28:31], s46 offen lds
    s_add_u32 s46, s46, 1024
    s_add_u32 s47, s47, 1024
    s_mov_b32 m0, s47
    s_nop 0
    buffer_load_dwordx4 v20, s[28:31], s46 offen lds
    s_add_u32 s46, s46, 1024
    s_add_u32 s47, s47, 1024
    s_mov_b32 m0, s47
    s_nop 0
    buffer_load_dwordx4 v20, s[28:31], s46 offen lds
    s_add_u32 s46, s46, 1024
    s_add_u32 s47, s47, 1024
    s_mov_b32 m0, s47
    s_nop 0
    buffer_load_dwordx4 v20, s[28:31], s46 offen lds
    s_add_u32 s46, s46, 1024
    s_add_u32 s47, s47, 1024
    s_mov_b32 m0, s47
    s_nop 0
    buffer_load_dwordx4 v20, s[28:31], s46 offen lds
    s_add_u32 s46, s46, 1024
    s_add_u32 s47, s47, 1024
    s_mov_b32 m0, s47
    s_nop 0
    buffer_load_dwordx4 v20, s[28:31], s46 offen lds
    s_add_u32 s46, s46, 1024
    s_add_u32 s47, s47, 1024
    s_mov_b32 m0, s47
    s_nop 0
    buffer_load_dwordx4 v20, s[28:31], s46 offen lds
    s_add_u32 s46, s46, 1024
    s_add_u32 s47, s47, 1024
    s_mov_b32 m0, s47
    s_nop 0
    buffer_load_dwordx4 v20, s[28:31], s46 offen lds
    s_add_u32 s46, s46, 1024
    s_add_u32 s47, s47, 1024
    s_mov_b32 m0, s47
    s_nop 0
    buffer_load_dwordx4 v20, s[28:31], s46 offen lds
    s_add_u32 s46, s46, 1024
    s_add_u32 s47, s47, 1024
    s_mov_b32 m0, s47
    s_nop 0
    buffer_load_dwordx4 v20, s[28:31], s46 offen lds
    s_add_u32 s46, s46, 1024
    s_add_u32 s47, s47, 1024
    s_mov_b32 m0, s47
    v_cmp_gt_u32 vcc, 32, v0
    s_and_saveexec_b64 s[48:49], vcc
    buffer_load_dwordx4 v20, s[28:31], s46 offen lds
    s_mov_b64 exec, s[48:49]
    s_add_u32 s46, s46, 1024
    s_add_u32 s47, s47, 1024
    s_waitcnt vmcnt(0)
    s_branch kvB_13
kvA_12:
    s_mov_b32 s56, s16
    s_mov_b32 s57, s17
    s_mov_b32 s58, s18
    s_mov_b32 s59, s19
    s_mul_i32 s46, s73, 40960
    s_add_u32 s60, s45, s46
    s_mov_b32 s61, 128
    s_mov_b32 s62, 0
    s_mov_b32 s63, 10240
    s_mov_b32 s64, 20480
    s_mov_b32 s65, 30720
    v_lshrrev_b32 v1, 4, v0
    v_add_u32 v1, 0, v1
    v_and_b32 v20, 7, v0
    v_xor_b32 v1, v1, v20
    v_lshrrev_b32 v20, 3, v0
    v_mul_u32_u24 v20, 1280, v20
    v_lshl_add_u32 v20, v1, 4, v20
    v_lshrrev_b32 v1, 4, v0
    v_add_u32 v1, 4, v1
    v_and_b32 v21, 7, v0
    v_xor_b32 v1, v1, v21
    v_lshrrev_b32 v21, 3, v0
    v_mul_u32_u24 v21, 1280, v21
    v_lshl_add_u32 v21, v1, 4, v21
    s_sub_u32 s70, s70, 8192
kvB_13:
    v_lshrrev_b32 v25, 4, v0
    v_lshrrev_b32 v24, 1, v25
    v_lshlrev_b32 v24, 3, v24
    v_bfe_u32 v26, v0, 2, 2
    v_add_u32 v24, v24, v26
    v_mul_u32_u24 v24, 40, v24
    v_and_b32 v25, 1, v25
    v_lshl_add_u32 v24, v25, 5, v24
    v_and_b32 v26, 3, v0
    v_lshl_add_u32 v24, v26, 3, v24
    v_add_u32 v24, 36864, v24
    s_lshl_b32 s46, s40, 12
    v_and_b32 v33, 31, v0
    v_lshrrev_b32 v34, 5, v0
    v_bfe_u32 v35, v0, 1, 3
    v_xor_b32 v34, v34, v35
    v_lshlrev_b32 v34, 4, v34
    v_lshl_add_u32 v32, v33, 7, v34
    v_add_u32 v32, s46, v32
    v_xor_b32 v33, 32, v32
    v_xor_b32 v34, 64, v32
    v_xor_b32 v35, 96, v32
    s_mov_b32 s74, 0
    s_mov_b32 s90, 0
    s_mov_b32 s91, 0
    s_cmp_lt_u32 s3, 2
    s_cbranch_scc1 kvd_14
    s_add_u32 s71, s70, s74
    s_mov_b32 m0, s71
    s_add_u32 s72, s60, s62
    buffer_load_dwordx4 v20, s[56:59], s72 offen lds
    s_add_u32 s71, s70, s74
    s_add_u32 s71, s71, 1024
    s_mov_b32 m0, s71
    s_add_u32 s72, s60, s63
    buffer_load_dwordx4 v21, s[56:59], s72 offen lds
    s_add_u32 s71, s70, s74
    s_add_u32 s71, s71, 2048
    s_mov_b32 m0, s71
    s_add_u32 s72, s60, s64
    buffer_load_dwordx4 v20, s[56:59], s72 offen lds
    s_add_u32 s71, s70, s74
    s_add_u32 s71, s71, 3072
    s_mov_b32 m0, s71
    s_add_u32 s72, s60, s65
    buffer_load_dwordx4 v21, s[56:59], s72 offen lds
    s_add_u32 s60, s60, s61
kvd_14:
    s_add_u32 s74, s74, 8192
    s_and_b32 s74, s74, 32767
    s_cmp_lt_u32 s3, 2
    s_cbranch_scc1 kvd_15
    s_add_u32 s71, s70, s74
    s_mov_b32 m0, s71
    s_add_u32 s72, s60, s62
    buffer_load_dwordx4 v20, s[56:59], s72 offen lds
    s_add_u32 s71, s70, s74
    s_add_u32 s71, s71, 1024
    s_mov_b32 m0, s71
    s_add_u32 s72, s60, s63
    buffer_load_dwordx4 v21, s[56:59], s72 offen lds
    s_add_u32 s71, s70, s74
    s_add_u32 s71, s71, 2048
    s_mov_b32 m0, s71
    s_add_u32 s72, s60, s64
    buffer_load_dwordx4 v20, s[56:59], s72 offen lds
    s_add_u32 s71, s70, s74
    s_add_u32 s71, s71, 3072
    s_mov_b32 m0, s71
    s_add_u32 s72, s60, s65
    buffer_load_dwordx4 v21, s[56:59], s72 offen lds
    s_add_u32 s60, s60, s61
kvd_15:
    s_add_u32 s74, s74, 8192
    s_and_b32 s74, s74, 32767
    s_cmp_lt_u32 s3, 2
    s_cbranch_scc1 kvd_16
    s_add_u32 s71, s70, s74
    s_mov_b32 m0, s71
    s_add_u32 s72, s60, s62
    buffer_load_dwordx4 v20, s[56:59], s72 offen lds
    s_add_u32 s71, s70, s74
    s_add_u32 s71, s71, 1024
    s_mov_b32 m0, s71
    s_add_u32 s72, s60, s63
    buffer_load_dwordx4 v21, s[56:59], s72 offen lds
    s_add_u32 s71, s70, s74
    s_add_u32 s71, s71, 2048
    s_mov_b32 m0, s71
    s_add_u32 s72, s60, s64
    buffer_load_dwordx4 v20, s[56:59], s72 offen lds
    s_add_u32 s71, s70, s74
    s_add_u32 s71, s71, 3072
    s_mov_b32 m0, s71
    s_add_u32 s72, s60, s65
    buffer_load_dwordx4 v21, s[56:59], s72 offen lds
    s_add_u32 s60, s60, s61
kvd_16:
    s_add_u32 s74, s74, 8192
    s_and_b32 s74, s74, 32767
    s_cmp_eq_u32 s43, 1
    s_cbranch_scc1 kvV_17
kl_19:
    s_cmp_lt_u32 s91, 7
    s_cbranch_scc0 kn_20
    s_waitcnt vmcnt(8)
    s_barrier
    s_cmp_lt_u32 s3, 2
    s_cbranch_scc1 kvd_22
    s_add_u32 s71, s70, s74
    s_mov_b32 m0, s71
    s_add_u32 s72, s60, s62
    buffer_load_dwordx4 v20, s[56:59], s72 offen lds
    s_add_u32 s71, s70, s74
    s_add_u32 s71, s71, 1024
    s_mov_b32 m0, s71
    s_add_u32 s72, s60, s63
    buffer_load_dwordx4 v21, s[56:59], s72 offen lds
    s_add_u32 s71, s70, s74
    s_add_u32 s71, s71, 2048
    s_mov_b32 m0, s71
    s_add_u32 s72, s60, s64
    buffer_load_dwordx4 v20, s[56:59], s72 offen lds
    s_add_u32 s71, s70, s74
    s_add_u32 s71, s71, 3072
    s_mov_b32 m0, s71
    s_add_u32 s72, s60, s65
    buffer_load_dwordx4 v21, s[56:59], s72 offen lds
    s_add_u32 s60, s60, s61
kvd_22:
    s_add_u32 s74, s74, 8192
    s_and_b32 s74, s74, 32767
    s_branch kg_21
kn_20:
    s_waitcnt vmcnt(0)
    s_barrier
kg_21:
    v_add_u32 v40, s90, v32
    v_add_u32 v41, s90, v33
    v_add_u32 v42, s90, v34
    v_add_u32 v43, s90, v35
    ds_read_b64_tr_b16 v[80:81], v24 offset:0
    ds_read_b64_tr_b16 v[82:83], v24 offset:160
    ds_read_b128 v[84:87], v40
    ds_read_b64_tr_b16 v[88:89], v24 offset:640
    ds_read_b64_tr_b16 v[90:91], v24 offset:800
    ds_read_b128 v[92:95], v41
    ds_read_b64_tr_b16 v[96:97], v24 offset:1280
    ds_read_b64_tr_b16 v[98:99], v24 offset:1440
    ds_read_b128 v[100:103], v42
    ds_read_b64_tr_b16 v[104:105], v24 offset:1920
    ds_read_b64_tr_b16 v[106:107], v24 offset:2080
    ds_read_b128 v[108:111], v43
    v_add_u32 v24, 2560, v24
    s_add_u32 s90, s90, 8192
    s_and_b32 s90, s90, 32767
    s_add_u32 s91, s91, 1
    s_waitcnt lgkmcnt(9)
    v_mfma_f32_32x32x16_bf16 v[48:63], v[80:83], v[84:87], v[48:63]
    s_waitcnt lgkmcnt(6)
    v_mfma_f32_32x32x16_bf16 v[48:63], v[88:91], v[92:95], v[48:63]
    s_waitcnt lgkmcnt(3)
    v_mfma_f32_32x32x16_bf16 v[48:63], v[96:99], v[100:103], v[48:63]
    s_waitcnt lgkmcnt(0)
    v_mfma_f32_32x32x16_bf16 v[48:63], v[104:107], v[108:111], v[48:63]
    s_cmp_lt_u32 s91, 10
    s_cbranch_scc1 kl_19
    s_nop 15
    s_cmp_lg_u32 s41, 0
    s_cbranch_scc1 P_end
    s_lshl_b32 s46, s42, 1
    s_add_u32 s46, s46, s40
    v_cvt_pk_bf16_f32 v64, v48, v49
    v_cvt_pk_bf16_f32 v65, v50, v51
    v_cvt_pk_bf16_f32 v66, v52, v53
    v_cvt_pk_bf16_f32 v67, v54, v55
    v_cvt_pk_bf16_f32 v68, v56, v57
    v_cvt_pk_bf16_f32 v69, v58, v59
    v_lshlrev_b32 v4, 4, v2
    v_lshl_add_u32 v4, v3, 3, v4
    s_lshr_b32 s47, s46, 3
    s_mul_i32 s47, s47, 21504
    s_add_u32 s47, s47, 2621440
    s_and_b32 s46, s46, 7
    s_lshl_b32 s48, s46, 10
    s_add_u32 s48, s48, s47
    buffer_store_dwordx2 v[64:65], v4, s[24:27], s48 offen
    buffer_store_dwordx2 v[66:67], v4, s[24:27], s48 offen offset:512
    s_lshl_b32 s48, s46, 8
    s_add_u32 s48, s48, s47
    s_add_u32 s48, s48, 8192
    v_lshlrev_b32 v4, 3, v2
    v_cmp_gt_u32 vcc, 32, v0
    s_and_saveexec_b64 s[50:51], vcc
    buffer_store_dwordx2 v[68:69], v4, s[24:27], s48 offen
    s_mov_b64 exec, s[50:51]
    s_branch P_end
kvV_17:
kl_23:
    s_cmp_lt_u32 s91, 7
    s_cbranch_scc0 kn_24
    s_waitcnt vmcnt(8)
    s_barrier
    s_cmp_lt_u32 s3, 2
    s_cbranch_scc1 kvd_26
    s_add_u32 s71, s70, s74
    s_mov_b32 m0, s71
    s_add_u32 s72, s60, s62
    buffer_load_dwordx4 v20, s[56:59], s72 offen lds
    s_add_u32 s71, s70, s74
    s_add_u32 s71, s71, 1024
    s_mov_b32 m0, s71
    s_add_u32 s72, s60, s63
    buffer_load_dwordx4 v21, s[56:59], s72 offen lds
    s_add_u32 s71, s70, s74
    s_add_u32 s71, s71, 2048
    s_mov_b32 m0, s71
    s_add_u32 s72, s60, s64
    buffer_load_dwordx4 v20, s[56:59], s72 offen lds
    s_add_u32 s71, s70, s74
    s_add_u32 s71, s71, 3072
    s_mov_b32 m0, s71
    s_add_u32 s72, s60, s65
    buffer_load_dwordx4 v21, s[56:59], s72 offen lds
    s_add_u32 s60, s60, s61
kvd_26:
    s_add_u32 s74, s74, 8192
    s_and_b32 s74, s74, 32767
    s_branch kg_25
kn_24:
    s_waitcnt vmcnt(0)
    s_barrier
kg_25:
    v_add_u32 v40, s90, v32
    v_add_u32 v41, s90, v33
    v_add_u32 v42, s90, v34
    v_add_u32 v43, s90, v35
    ds_read_b64_tr_b16 v[80:81], v24 offset:0
    ds_read_b64_tr_b16 v[82:83], v24 offset:160
    ds_read_b128 v[84:87], v40
    ds_read_b64_tr_b16 v[88:89], v24 offset:640
    ds_read_b64_tr_b16 v[90:91], v24 offset:800
    ds_read_b128 v[92:95], v41
    ds_read_b64_tr_b16 v[96:97], v24 offset:1280
    ds_read_b64_tr_b16 v[98:99], v24 offset:1440
    ds_read_b128 v[100:103], v42
    ds_read_b64_tr_b16 v[104:105], v24 offset:1920
    ds_read_b64_tr_b16 v[106:107], v24 offset:2080
    ds_read_b128 v[108:111], v43
    v_add_u32 v24, 2560, v24
    s_add_u32 s90, s90, 8192
    s_and_b32 s90, s90, 32767
    s_add_u32 s91, s91, 1
    s_waitcnt lgkmcnt(9)
    v_mfma_f32_32x32x16_bf16 v[48:63], v[84:87], v[80:83], v[48:63]
    s_waitcnt lgkmcnt(6)
    v_mfma_f32_32x32x16_bf16 v[48:63], v[92:95], v[88:91], v[48:63]
    s_waitcnt lgkmcnt(3)
    v_mfma_f32_32x32x16_bf16 v[48:63], v[100:103], v[96:99], v[48:63]
    s_waitcnt lgkmcnt(0)
    v_mfma_f32_32x32x16_bf16 v[48:63], v[108:111], v[104:107], v[48:63]
    s_cmp_lt_u32 s91, 10
    s_cbranch_scc1 kl_23
    s_nop 15
    s_cmp_lg_u32 s41, 0
    s_cbranch_scc1 P_end
    s_lshl_b32 s46, s42, 1
    s_add_u32 s46, s46, s40
    s_lshr_b32 s47, s46, 3
    s_mul_i32 s47, s47, 21504
    s_add_u32 s47, s47, 2631680
    s_and_b32 s46, s46, 7
    s_mul_i32 s46, s46, 1344
    s_add_u32 s47, s47, s46
    v_cvt_pk_bf16_f32 v64, v48, v49
    v_cvt_pk_bf16_f32 v65, v50, v51
    v_cvt_pk_bf16_f32 v66, v52, v53
    v_cvt_pk_bf16_f32 v67, v54, v55
    v_cvt_pk_bf16_f32 v68, v56, v57
    v_cvt_pk_bf16_f32 v69, v58, v59
    v_cvt_pk_bf16_f32 v70, v60, v61
    v_cvt_pk_bf16_f32 v71, v62, v63
    v_mov_b32 v72, 0x3f803f80
    v_cmp_eq_u32 vcc, 20, v2
    s_nop 1
    v_cndmask_b32 v64, v64, v72, vcc
    v_cndmask_b32 v65, v65, v72, vcc
    v_cndmask_b32 v66, v66, v72, vcc
    v_cndmask_b32 v67, v67, v72, vcc
    v_cndmask_b32 v68, v68, v72, vcc
    v_cndmask_b32 v69, v69, v72, vcc
    v_cndmask_b32 v70, v70, v72, vcc
    v_cndmask_b32 v71, v71, v72, vcc
    v_mul_u32_u24 v4, 21, v3
    v_add_u32 v4, v4, v2
    v_lshlrev_b32 v4, 4, v4
    v_cmp_gt_u32 vcc, 21, v2
    s_and_saveexec_b64 s[50:51], vcc
    buffer_store_dwordx4 v[64:67], v4, s[24:27], s47 offen
    buffer_store_dwordx4 v[68:71], v4, s[24:27], s47 offen offset:672
    s_mov_b64 exec, s[50:51]
    s_branch P_end
P_stats:
    s_sub_u32 s42, s2, 384
    s_lshl_b32 s42, s42, 3
    s_lshl_b32 s43, s3, 1
    s_add_u32 s42, s42, s43
    v_mul_u32_u24 v1, 20, v0
    buffer_load_dword v70, v1, s[36:39], 0 offen offset:0
    buffer_load_dword v71, v1, s[36:39], 0 offen offset:4
    buffer_load_dword v72, v1, s[36:39], 0 offen offset:8
    buffer_load_dword v73, v1, s[36:39], 0 offen offset:12
    buffer_load_dword v74, v1, s[36:39], 0 offen offset:16
    s_mul_i32 s43, s42, 1280
    buffer_load_dword v80, v1, s[16:19], s43 offen offset:0
    buffer_load_dword v81, v1, s[16:19], s43 offen offset:4
    buffer_load_dword v82, v1, s[16:19], s43 offen offset:8
    buffer_load_dword v83, v1, s[16:19], s43 offen offset:12
    buffer_load_dword v84, v1, s[16:19], s43 offen offset:16
    s_add_u32 s43, s43, 1280
    buffer_load_dword v85, v1, s[16:19], s43 offen offset:0
    buffer_load_dword v86, v1, s[16:19], s43 offen offset:4
    buffer_load_dword v87, v1, s[16:19], s43 offen offset:8
    buffer_load_dword v88, v1, s[16:19], s43 offen offset:12
    buffer_load_dword v89, v1, s[16:19], s43 offen offset:16
    s_add_u32 s43, s43, 1280
    s_waitcnt vmcnt(10)
    v_lshlrev_b32 v50, 16, v70
    v_and_b32 v51, 0xffff0000, v70
    v_lshlrev_b32 v52, 16, v71
    v_and_b32 v53, 0xffff0000, v71
    v_lshlrev_b32 v54, 16, v72
    v_and_b32 v55, 0xffff0000, v72
    v_lshlrev_b32 v56, 16, v73
    v_and_b32 v57, 0xffff0000, v73
    v_lshlrev_b32 v58, 16, v74
    v_and_b32 v59, 0xffff0000, v74
    s_mov_b32 s44, 986500301
    s_mov_b32 s45, 925353388
    s_mov_b32 s46, 3216550459
    s_mul_i32 s43, s42, 1280
    s_add_u32 s43, s43, 2818048
    s_lshl_b32 s47, s42, 2
    s_add_u32 s47, s47, 2793472
    v_mov_b32 v60, 0
    s_waitcnt vmcnt(0)
    v_lshlrev_b32 v10, 16, v80
    v_and_b32 v11, 0xffff0000, v80
    v_lshlrev_b32 v12, 16, v81
    v_and_b32 v13, 0xffff0000, v81
    v_lshlrev_b32 v14, 16, v82
    v_and_b32 v15, 0xffff0000, v82
    v_lshlrev_b32 v16, 16, v83
    v_and_b32 v17, 0xffff0000, v83
    v_lshlrev_b32 v18, 16, v84
    v_and_b32 v19, 0xffff0000, v84
    v_add_f32 v30, v10, v11
    v_mul_f32 v31, v10, v50
    v_fmac_f32 v31, v11, v51
    v_add_f32 v30, v30, v12
    v_fmac_f32 v31, v12, v52
    v_add_f32 v30, v30, v13
    v_fmac_f32 v31, v13, v53
    v_add_f32 v30, v30, v14
    v_fmac_f32 v31, v14, v54
    v_add_f32 v30, v30, v15
    v_fmac_f32 v31, v15, v55
    v_add_f32 v30, v30, v16
    v_fmac_f32 v31, v16, v56
    v_add_f32 v30, v30, v17
    v_fmac_f32 v31, v17, v57
    v_add_f32 v30, v30, v18
    v_fmac_f32 v31, v18, v58
    v_add_f32 v30, v30, v19
    v_fmac_f32 v31, v19, v59
    s_nop 1
    v_add_f32_dpp v30, v30, v30 quad_perm:[1,0,3,2] row_mask:0xf bank_mask:0xf
    s_nop 1
    v_add_f32_dpp v30, v30, v30 quad_perm:[2,3,0,1] row_mask:0xf bank_mask:0xf
    s_nop 1
    v_add_f32_dpp v30, v30, v30 row_half_mirror row_mask:0xf bank_mask:0xf
    s_nop 1
    v_add_f32_dpp v30, v30, v30 row_mirror row_mask:0xf bank_mask:0xf
    v_mov_b32 v32, v30
    s_nop 1
    v_permlane16_swap_b32 v32, v30
    s_nop 1
    v_add_f32 v30, v30, v32
    v_mov_b32 v32, v30
    s_nop 1
    v_permlane32_swap_b32 v32, v30
    s_nop 1
    v_add_f32 v30, v30, v32
    s_nop 1
    v_add_f32_dpp v31, v31, v31 quad_perm:[1,0,3,2] row_mask:0xf bank_mask:0xf
    s_nop 1
    v_add_f32_dpp v31, v31, v31 quad_perm:[2,3,0,1] row_mask:0xf bank_mask:0xf
    s_nop 1
    v_add_f32_dpp v31, v31, v31 row_half_mirror row_mask:0xf bank_mask:0xf
    s_nop 1
    v_add_f32_dpp v31, v31, v31 row_mirror row_mask:0xf bank_mask:0xf
    v_mov_b32 v32, v31
    s_nop 1
    v_permlane16_swap_b32 v32, v31
    s_nop 1
    v_add_f32 v31, v31, v32
    v_mov_b32 v32, v31
    s_nop 1
    v_permlane32_swap_b32 v32, v31
    s_nop 1
    v_add_f32 v31, v31, v32
    v_mul_f32 v30, s44, v30
    v_sub_f32 v10, v10, v30
    v_sub_f32 v11, v11, v30
    v_sub_f32 v12, v12, v30
    v_sub_f32 v13, v13, v30
    v_sub_f32 v14, v14, v30
    v_sub_f32 v15, v15, v30
    v_sub_f32 v16, v16, v30
    v_sub_f32 v17, v17, v30
    v_sub_f32 v18, v18, v30
    v_sub_f32 v19, v19, v30
    v_mul_f32 v33, v10, v10
    v_fmac_f32 v33, v11, v11
    v_fmac_f32 v33, v12, v12
    v_fmac_f32 v33, v13, v13
    v_fmac_f32 v33, v14, v14
    v_fmac_f32 v33, v15, v15
    v_fmac_f32 v33, v16, v16
    v_fmac_f32 v33, v17, v17
    v_fmac_f32 v33, v18, v18
    v_fmac_f32 v33, v19, v19
    s_nop 1
    v_add_f32_dpp v33, v33, v33 quad_perm:[1,0,3,2] row_mask:0xf bank_mask:0xf
    s_nop 1
    v_add_f32_dpp v33, v33, v33 quad_perm:[2,3,0,1] row_mask:0xf bank_mask:0xf
    s_nop 1
    v_add_f32_dpp v33, v33, v33 row_half_mirror row_mask:0xf bank_mask:0xf
    s_nop 1
    v_add_f32_dpp v33, v33, v33 row_mirror row_mask:0xf bank_mask:0xf
    v_mov_b32 v32, v33
    s_nop 1
    v_permlane16_swap_b32 v32, v33
    s_nop 1
    v_add_f32 v33, v33, v32
    v_mov_b32 v32, v33
    s_nop 1
    v_permlane32_swap_b32 v32, v33
    s_nop 1
    v_add_f32 v33, v33, v32
    v_mov_b32 v34, s45
    v_fmac_f32 v34, s44, v33
    v_rsq_f32 v34, v34
    v_mul_f32 v35, s46, v31
    v_exp_f32 v35, v35
    s_nop 0
    v_add_f32 v35, 1.0, v35
    v_rcp_f32 v35, v35
    v_mul_f32 v10, v10, v34
    v_mul_f32 v11, v11, v34
    v_mul_f32 v12, v12, v34
    v_mul_f32 v13, v13, v34
    v_mul_f32 v14, v14, v34
    v_mul_f32 v15, v15, v34
    v_mul_f32 v16, v16, v34
    v_mul_f32 v17, v17, v34
    v_mul_f32 v18, v18, v34
    v_mul_f32 v19, v19, v34
    v_cvt_pk_bf16_f32 v40, v10, v11
    v_cvt_pk_bf16_f32 v41, v12, v13
    v_cvt_pk_bf16_f32 v42, v14, v15
    v_cvt_pk_bf16_f32 v43, v16, v17
    v_cvt_pk_bf16_f32 v44, v18, v19
    buffer_store_dword v40, v1, s[24:27], s43 offen offset:0
    buffer_store_dword v41, v1, s[24:27], s43 offen offset:4
    buffer_store_dword v42, v1, s[24:27], s43 offen offset:8
    buffer_store_dword v43, v1, s[24:27], s43 offen offset:12
    buffer_store_dword v44, v1, s[24:27], s43 offen offset:16
    v_cmp_eq_u32 vcc, 0, v0
    s_and_saveexec_b64 s[50:51], vcc
    buffer_store_dword v35, v60, s[24:27], s47 offen
    s_mov_b64 exec, s[50:51]
    s_add_u32 s43, s43, 1280
    s_add_u32 s47, s47, 4
    s_nop 1
    v_lshlrev_b32 v10, 16, v85
    v_and_b32 v11, 0xffff0000, v85
    v_lshlrev_b32 v12, 16, v86
    v_and_b32 v13, 0xffff0000, v86
    v_lshlrev_b32 v14, 16, v87
    v_and_b32 v15, 0xffff0000, v87
    v_lshlrev_b32 v16, 16, v88
    v_and_b32 v17, 0xffff0000, v88
    v_lshlrev_b32 v18, 16, v89
    v_and_b32 v19, 0xffff0000, v89
    v_add_f32 v30, v10, v11
    v_mul_f32 v31, v10, v50
    v_fmac_f32 v31, v11, v51
    v_add_f32 v30, v30, v12
    v_fmac_f32 v31, v12, v52
    v_add_f32 v30, v30, v13
    v_fmac_f32 v31, v13, v53
    v_add_f32 v30, v30, v14
    v_fmac_f32 v31, v14, v54
    v_add_f32 v30, v30, v15
    v_fmac_f32 v31, v15, v55
    v_add_f32 v30, v30, v16
    v_fmac_f32 v31, v16, v56
    v_add_f32 v30, v30, v17
    v_fmac_f32 v31, v17, v57
    v_add_f32 v30, v30, v18
    v_fmac_f32 v31, v18, v58
    v_add_f32 v30, v30, v19
    v_fmac_f32 v31, v19, v59
    s_nop 1
    v_add_f32_dpp v30, v30, v30 quad_perm:[1,0,3,2] row_mask:0xf bank_mask:0xf
    s_nop 1
    v_add_f32_dpp v30, v30, v30 quad_perm:[2,3,0,1] row_mask:0xf bank_mask:0xf
    s_nop 1
    v_add_f32_dpp v30, v30, v30 row_half_mirror row_mask:0xf bank_mask:0xf
    s_nop 1
    v_add_f32_dpp v30, v30, v30 row_mirror row_mask:0xf bank_mask:0xf
    v_mov_b32 v32, v30
    s_nop 1
    v_permlane16_swap_b32 v32, v30
    s_nop 1
    v_add_f32 v30, v30, v32
    v_mov_b32 v32, v30
    s_nop 1
    v_permlane32_swap_b32 v32, v30
    s_nop 1
    v_add_f32 v30, v30, v32
    s_nop 1
    v_add_f32_dpp v31, v31, v31 quad_perm:[1,0,3,2] row_mask:0xf bank_mask:0xf
    s_nop 1
    v_add_f32_dpp v31, v31, v31 quad_perm:[2,3,0,1] row_mask:0xf bank_mask:0xf
    s_nop 1
    v_add_f32_dpp v31, v31, v31 row_half_mirror row_mask:0xf bank_mask:0xf
    s_nop 1
    v_add_f32_dpp v31, v31, v31 row_mirror row_mask:0xf bank_mask:0xf
    v_mov_b32 v32, v31
    s_nop 1
    v_permlane16_swap_b32 v32, v31
    s_nop 1
    v_add_f32 v31, v31, v32
    v_mov_b32 v32, v31
    s_nop 1
    v_permlane32_swap_b32 v32, v31
    s_nop 1
    v_add_f32 v31, v31, v32
    v_mul_f32 v30, s44, v30
    v_sub_f32 v10, v10, v30
    v_sub_f32 v11, v11, v30
    v_sub_f32 v12, v12, v30
    v_sub_f32 v13, v13, v30
    v_sub_f32 v14, v14, v30
    v_sub_f32 v15, v15, v30
    v_sub_f32 v16, v16, v30
    v_sub_f32 v17, v17, v30
    v_sub_f32 v18, v18, v30
    v_sub_f32 v19, v19, v30
    v_mul_f32 v33, v10, v10
    v_fmac_f32 v33, v11, v11
    v_fmac_f32 v33, v12, v12
    v_fmac_f32 v33, v13, v13
    v_fmac_f32 v33, v14, v14
    v_fmac_f32 v33, v15, v15
    v_fmac_f32 v33, v16, v16
    v_fmac_f32 v33, v17, v17
    v_fmac_f32 v33, v18, v18
    v_fmac_f32 v33, v19, v19
    s_nop 1
    v_add_f32_dpp v33, v33, v33 quad_perm:[1,0,3,2] row_mask:0xf bank_mask:0xf
    s_nop 1
    v_add_f32_dpp v33, v33, v33 quad_perm:[2,3,0,1] row_mask:0xf bank_mask:0xf
    s_nop 1
    v_add_f32_dpp v33, v33, v33 row_half_mirror row_mask:0xf bank_mask:0xf
    s_nop 1
    v_add_f32_dpp v33, v33, v33 row_mirror row_mask:0xf bank_mask:0xf
    v_mov_b32 v32, v33
    s_nop 1
    v_permlane16_swap_b32 v32, v33
    s_nop 1
    v_add_f32 v33, v33, v32
    v_mov_b32 v32, v33
    s_nop 1
    v_permlane32_swap_b32 v32, v33
    s_nop 1
    v_add_f32 v33, v33, v32
    v_mov_b32 v34, s45
    v_fmac_f32 v34, s44, v33
    v_rsq_f32 v34, v34
    v_mul_f32 v35, s46, v31
    v_exp_f32 v35, v35
    s_nop 0
    v_add_f32 v35, 1.0, v35
    v_rcp_f32 v35, v35
    v_mul_f32 v10, v10, v34
    v_mul_f32 v11, v11, v34
    v_mul_f32 v12, v12, v34
    v_mul_f32 v13, v13, v34
    v_mul_f32 v14, v14, v34
    v_mul_f32 v15, v15, v34
    v_mul_f32 v16, v16, v34
    v_mul_f32 v17, v17, v34
    v_mul_f32 v18, v18, v34
    v_mul_f32 v19, v19, v34
    v_cvt_pk_bf16_f32 v40, v10, v11
    v_cvt_pk_bf16_f32 v41, v12, v13
    v_cvt_pk_bf16_f32 v42, v14, v15
    v_cvt_pk_bf16_f32 v43, v16, v17
    v_cvt_pk_bf16_f32 v44, v18, v19
    buffer_store_dword v40, v1, s[24:27], s43 offen offset:0
    buffer_store_dword v41, v1, s[24:27], s43 offen offset:4
    buffer_store_dword v42, v1, s[24:27], s43 offen offset:8
    buffer_store_dword v43, v1, s[24:27], s43 offen offset:12
    buffer_store_dword v44, v1, s[24:27], s43 offen offset:16
    v_cmp_eq_u32 vcc, 0, v0
    s_and_saveexec_b64 s[50:51], vcc
    buffer_store_dword v35, v60, s[24:27], s47 offen
    s_mov_b64 exec, s[50:51]
    s_add_u32 s43, s43, 1280
    s_add_u32 s47, s47, 4
    s_nop 1
P_end:
    s_endpgm
    .text
    .globl mid_kernel
    .p2align 8
    .type mid_kernel,@function
mid_kernel:
    s_cmp_ge_u32 s2, 496
    s_cbranch_scc1 M_exit
    s_cmp_ge_u32 s2, 256
    s_cbranch_scc1 M_gemm
    s_load_dwordx2 s[14:15], s[0:1], 104
    s_load_dwordx2 s[4:5], s[0:1], 64
    s_load_dwordx2 s[6:7], s[0:1], 32
    v_lshrrev_b32 v1, 6, v0
    v_and_b32 v0, 63, v0
    s_nop 0
    v_readfirstlane_b32 s3, v1
    s_waitcnt lgkmcnt(0)
    s_mov_b32 s24, s14
    s_and_b32 s25, s15, 0xffff
    s_mov_b32 s26, 10027008
    s_mov_b32 s27, 0x00020000
    s_mov_b32 s84, s4
    s_and_b32 s85, s5, 0xffff
    s_mov_b32 s86, 6291456
    s_mov_b32 s87, 0x00020000
    s_mov_b32 s88, s6
    s_and_b32 s89, s7, 0xffff
    s_mov_b32 s90, 819200
    s_mov_b32 s91, 0x00020000
    v_and_b32 v2, 31, v0
    v_lshrrev_b32 v3, 5, v0
    v_lshlrev_b32 v44, 4, v0
    s_lshl_b32 s49, s3, 10
    s_mov_b32 s50, 2621440
    s_mov_b32 s51, 0
    s_add_u32 s46, s50, s49
    s_add_u32 s47, s51, s49
    s_mov_b32 m0, s47
    s_nop 0
    buffer_load_dwordx4 v44, s[24:27], s46 offen lds
    s_add_u32 s46, s46, 8192
    s_add_u32 s47, s47, 8192
    s_mov_b32 m0, s47
    s_nop 0
    buffer_load_dwordx4 v44, s[24:27], s46 offen lds
    s_add_u32 s46, s46, 8192
    s_add_u32 s47, s47, 8192
    s_cmp_ge_u32 s3, 5
    s_cbranch_scc1 ad_27
    s_mov_b32 m0, s47
    s_nop 0
    buffer_load_dwordx4 v44, s[24:27], s46 offen lds
    s_add_u32 s46, s46, 8192
    s_add_u32 s47, s47, 8192
ad_27:
    s_add_u32 s50, s50, 21504
    s_add_u32 s51, s51, 21504
    s_cmp_eq_u32 s51, 64512
    s_cselect_b32 s51, 0, s51
    s_add_u32 s46, s50, s49
    s_add_u32 s47, s51, s49
    s_mov_b32 m0, s47
    s_nop 0
    buffer_load_dwordx4 v44, s[24:27], s46 offen lds
    s_add_u32 s46, s46, 8192
    s_add_u32 s47, s47, 8192
    s_mov_b32 m0, s47
    s_nop 0
    buffer_load_dwordx4 v44, s[24:27], s46 offen lds
    s_add_u32 s46, s46, 8192
    s_add_u32 s47, s47, 8192
    s_cmp_ge_u32 s3, 5
    s_cbranch_scc1 ad_28
    s_mov_b32 m0, s47
    s_nop 0
    buffer_load_dwordx4 v44, s[24:27], s46 offen lds
    s_add_u32 s46, s46, 8192
    s_add_u32 s47, s47, 8192
ad_28:
    s_add_u32 s50, s50, 21504
    s_add_u32 s51, s51, 21504
    s_cmp_eq_u32 s51, 64512
    s_cselect_b32 s51, 0, s51
    s_lshl_b32 s40, s2, 3
    s_add_u32 s40, s40, s3
    s_mul_i32 s41, s40, 1280
    s_add_u32 s42, s41, 0
    v_mul_u32_u24 v125, 40, v2
    v_lshl_add_u32 v126, v3, 4, v125
    buffer_load_dwordx4 v[4:7], v126, s[24:27], s42 offen
    v_mov_b32 v8, 0
    v_mov_b32 v9, 0
    v_mov_b32 v10, 0
    v_mov_b32 v11, 0
    s_mov_b64 s[52:53], 0xffffffff
    s_mov_b32 s54, 0
    s_mov_b32 s55, -1
    s_mov_b64 exec, s[52:53]
    buffer_load_dwordx2 v[8:9], v125, s[24:27], s42 offen offset:32
    s_mov_b64 exec, -1
    v_mov_b32 v22, 0x3f803f80
    v_mov_b32 v23, 0x00003f80
    v_mov_b32 v26, 0x3f803f80
    v_mov_b32 v27, 0x00003f80
    v_lshlrev_b32 v45, 3, v2
    v_add_u32 v45, 8192, v45
    v_min_u32 v46, 20, v2
    v_mul_u32_u24 v125, 21, v3
    v_add_u32 v46, v46, v125
    v_lshlrev_b32 v46, 4, v46
    v_add_u32 v46, 10240, v46
    v_mov_b32 v47, v44
    v_add_u32 v50, 21504, v44
    v_mov_b32 v48, v45
    v_add_u32 v51, 21504, v45
    v_mov_b32 v49, v46
    v_add_u32 v52, 21504, v46
    v_mov_b32 v92, 0
    v_mov_b32 v93, 0
    v_mov_b32 v94, 0
    v_mov_b32 v95, 0
    v_mov_b32 v96, 0
    v_mov_b32 v97, 0
    v_mov_b32 v98, 0
    v_mov_b32 v99, 0
    v_mov_b32 v100, 0
    v_mov_b32 v101, 0
    v_mov_b32 v102, 0
    v_mov_b32 v103, 0
    v_mov_b32 v104, 0
    v_mov_b32 v105, 0
    v_mov_b32 v106, 0
    v_mov_b32 v107, 0
    v_mov_b32 v124, 0
    s_mov_b32 s56, 0
    s_waitcnt vmcnt(0)
    s_barrier
    ds_read_b128 v[12:15], v47 offset:0
    ds_read_b64 v[20:21], v48 offset:0
    ds_read_b128 v[16:19], v47 offset:1024
    ds_read_b64 v[24:25], v48 offset:256
    ds_read_b128 v[28:31], v49 offset:0
    ds_read_b128 v[32:35], v49 offset:672
    s_waitcnt lgkmcnt(0)
    v_mfma_f32_32x32x16_bf16 v[60:75], v[12:15], v[4:7], 0
    v_mfma_f32_32x32x16_bf16 v[60:75], v[20:23], v[8:11], v[60:75]
    s_nop 7
    s_nop 7
    v_max3_f32 v123, v60, v61, v62
    v_max3_f32 v123, v123, v63, v64
    v_max3_f32 v123, v123, v65, v66
    v_max3_f32 v123, v123, v67, v68
    v_max3_f32 v123, v123, v69, v70
    v_max3_f32 v123, v123, v71, v72
    v_max3_f32 v123, v123, v73, v74
    v_max_f32 v123, v123, v75
    v_mov_b32 v125, v123
    s_nop 1
    v_permlane32_swap_b32 v125, v123
    s_nop 1
    v_max_f32 v123, v123, v125
    v_sub_f32 v124, 0, v123
    v_cvt_pk_bf16_f32 v125, v124, v124
    v_lshlrev_b32 v125, 16, v125
    v_sub_f32 v126, v124, v125
    v_cvt_pk_bf16_f32 v125, v126, v126
    v_lshlrev_b32 v125, 16, v125
    v_sub_f32 v125, v126, v125
    s_mov_b64 exec, s[52:53]
    v_cvt_pk_bf16_f32 v10, v124, v126
    v_cvt_pk_bf16_f32 v11, v125, 0
    s_mov_b64 exec, -1
    s_nop 3
    v_mfma_f32_32x32x16_bf16 v[60:75], v[12:15], v[4:7], 0
    v_mfma_f32_32x32x16_bf16 v[60:75], v[20:23], v[8:11], v[60:75]
    s_nop 7
    s_mov_b32 s44, 0
    s_mov_b32 s45, 1090519040
    s_mov_b32 s48, 1266679808
A_loop:
    s_cmp_eq_u32 s44, 0
    s_cbranch_scc1 anb_29
    s_waitcnt vmcnt(0)
    s_barrier
anb_29:
    s_cmp_ge_u32 s44, 6
    s_cbranch_scc1 and_30
    s_add_u32 s46, s50, s49
    s_add_u32 s47, s51, s49
    s_mov_b32 m0, s47
    s_nop 0
    buffer_load_dwordx4 v44, s[24:27], s46 offen lds
    s_add_u32 s46, s46, 8192
    s_add_u32 s47, s47, 8192
    s_mov_b32 m0, s47
    s_nop 0
    buffer_load_dwordx4 v44, s[24:27], s46 offen lds
    s_add_u32 s46, s46, 8192
    s_add_u32 s47, s47, 8192
    s_cmp_ge_u32 s3, 5
    s_cbranch_scc1 ad_31
    s_mov_b32 m0, s47
    s_nop 0
    buffer_load_dwordx4 v44, s[24:27], s46 offen lds
    s_add_u32 s46, s46, 8192
    s_add_u32 s47, s47, 8192
ad_31:
    s_add_u32 s50, s50, 21504
    s_add_u32 s51, s51, 21504
    s_cmp_eq_u32 s51, 64512
    s_cselect_b32 s51, 0, s51
and_30:
    s_cmp_ge_u32 s44, 4
    s_cbranch_scc1 apf_32
    s_lshl_b32 s46, s40, 2
    s_add_u32 s46, s46, s44
    s_lshl_b32 s46, s46, 10
    s_cmp_ge_u32 s46, 6291456
    s_cbranch_scc1 apw_33
    buffer_load_dwordx4 v[56:59], v44, s[84:87], s46 offen
    s_branch apf_32
apw_33:
    s_sub_u32 s46, s46, 6291456
    buffer_load_dwordx4 v[56:59], v44, s[88:91], s46 offen
apf_32:
    v_mov_b32 v108, v92
    v_mov_b32 v109, v93
    v_mov_b32 v110, v94
    v_mov_b32 v111, v95
    v_mov_b32 v112, v96
    v_mov_b32 v113, v97
    v_mov_b32 v114, v98
    v_mov_b32 v115, v99
    v_mov_b32 v116, v100
    v_mov_b32 v117, v101
    v_mov_b32 v118, v102
    v_mov_b32 v119, v103
    s_waitcnt lgkmcnt(0)
    ds_read_b128 v[12:15], v47 offset:2048
    ds_read_b64 v[20:21], v48 offset:512
    ds_read_b128 v[36:39], v49 offset:1344
    ds_read_b128 v[40:43], v49 offset:2016
    v_mfma_f32_32x32x16_bf16 v[76:91], v[16:19], v[4:7], 0
    v_mfma_f32_32x32x16_bf16 v[76:91], v[24:27], v[8:11], v[76:91]
    v_exp_f32 v60, v60
    v_exp_f32 v61, v61
    v_exp_f32 v62, v62
    v_exp_f32 v63, v63
    v_exp_f32 v64, v64
    v_exp_f32 v65, v65
    v_exp_f32 v66, v66
    v_exp_f32 v67, v67
    v_cvt_pk_bf16_f32 v60, v60, v61
    v_cvt_pk_bf16_f32 v61, v62, v63
    v_cvt_pk_bf16_f32 v62, v64, v65
    v_cvt_pk_bf16_f32 v63, v66, v67
    v_exp_f32 v68, v68
    v_exp_f32 v69, v69
    v_mfma_f32_32x32x16_bf16 v[92:107], v[28:31], v[60:63], v[92:107]
    v_exp_f32 v70, v70
    v_exp_f32 v71, v71
    v_exp_f32 v72, v72
    v_exp_f32 v73, v73
    v_exp_f32 v74, v74
    v_exp_f32 v75, v75
    v_cvt_pk_bf16_f32 v68, v68, v69
    v_cvt_pk_bf16_f32 v69, v70, v71
    v_cvt_pk_bf16_f32 v70, v72, v73
    v_cvt_pk_bf16_f32 v71, v74, v75
    s_nop 1
    v_mfma_f32_32x32x16_bf16 v[92:107], v[32:35], v[68:71], v[92:107]
    s_waitcnt lgkmcnt(0)
    ds_read_b128 v[16:19], v47 offset:3072
    ds_read_b64 v[24:25], v48 offset:768
    ds_read_b128 v[28:31], v49 offset:2688
    ds_read_b128 v[32:35], v49 offset:3360
    v_mfma_f32_32x32x16_bf16 v[60:75], v[12:15], v[4:7], 0
    v_mfma_f32_32x32x16_bf16 v[60:75], v[20:23], v[8:11], v[60:75]
    v_exp_f32 v76, v76
    v_exp_f32 v77, v77
    v_exp_f32 v78, v78
    v_exp_f32 v79, v79
    v_exp_f32 v80, v80
    v_exp_f32 v81, v81
    v_exp_f32 v82, v82
    v_exp_f32 v83, v83
    v_cvt_pk_bf16_f32 v76, v76, v77
    v_cvt_pk_bf16_f32 v77, v78, v79
    v_cvt_pk_bf16_f32 v78, v80, v81
    v_cvt_pk_bf16_f32 v79, v82, v83
    v_exp_f32 v84, v84
    v_exp_f32 v85, v85
    v_mfma_f32_32x32x16_bf16 v[92:107], v[36:39], v[76:79], v[92:107]
    v_exp_f32 v86, v86
    v_exp_f32 v87, v87
    v_exp_f32 v88, v88
    v_exp_f32 v89, v89
    v_exp_f32 v90, v90
    v_exp_f32 v91, v91
    v_cvt_pk_bf16_f32 v84, v84, v85
    v_cvt_pk_bf16_f32 v85, v86, v87
    v_cvt_pk_bf16_f32 v86, v88, v89
    v_cvt_pk_bf16_f32 v87, v90, v91
    s_nop 1
    v_mfma_f32_32x32x16_bf16 v[92:107], v[40:43], v[84:87], v[92:107]
    s_waitcnt lgkmcnt(0)
    ds_read_b128 v[12:15], v47 offset:4096
    ds_read_b64 v[20:21], v48 offset:1024
    ds_read_b128 v[36:39], v49 offset:4032
    ds_read_b128 v[40:43], v49 offset:4704
    v_mfma_f32_32x32x16_bf16 v[76:91], v[16:19], v[4:7], 0
    v_mfma_f32_32x32x16_bf16 v[76:91], v[24:27], v[8:11], v[76:91]
    v_exp_f32 v60, v60
    v_exp_f32 v61, v61
    v_exp_f32 v62, v62
    v_exp_f32 v63, v63
    v_exp_f32 v64, v64
    v_exp_f32 v65, v65
    v_exp_f32 v66, v66
    v_exp_f32 v67, v67
    v_cvt_pk_bf16_f32 v60, v60, v61
    v_cvt_pk_bf16_f32 v61, v62, v63
    v_cvt_pk_bf16_f32 v62, v64, v65
    v_cvt_pk_bf16_f32 v63, v66, v67
    v_exp_f32 v68, v68
    v_exp_f32 v69, v69
    v_mfma_f32_32x32x16_bf16 v[92:107], v[28:31], v[60:63], v[92:107]
    v_exp_f32 v70, v70
    v_exp_f32 v71, v71
    v_exp_f32 v72, v72
    v_exp_f32 v73, v73
    v_exp_f32 v74, v74
    v_exp_f32 v75, v75
    v_cvt_pk_bf16_f32 v68, v68, v69
    v_cvt_pk_bf16_f32 v69, v70, v71
    v_cvt_pk_bf16_f32 v70, v72, v73
    v_cvt_pk_bf16_f32 v71, v74, v75
    s_nop 1
    v_mfma_f32_32x32x16_bf16 v[92:107], v[32:35], v[68:71], v[92:107]
    s_waitcnt lgkmcnt(0)
    ds_read_b128 v[16:19], v47 offset:5120
    ds_read_b64 v[24:25], v48 offset:1280
    ds_read_b128 v[28:31], v49 offset:5376
    ds_read_b128 v[32:35], v49 offset:6048
    v_mfma_f32_32x32x16_bf16 v[60:75], v[12:15], v[4:7], 0
    v_mfma_f32_32x32x16_bf16 v[60:75], v[20:23], v[8:11], v[60:75]
    v_exp_f32 v76, v76
    v_exp_f32 v77, v77
    v_exp_f32 v78, v78
    v_exp_f32 v79, v79
    v_exp_f32 v80, v80
    v_exp_f32 v81, v81
    v_exp_f32 v82, v82
    v_exp_f32 v83, v83
    v_cvt_pk_bf16_f32 v76, v76, v77
    v_cvt_pk_bf16_f32 v77, v78, v79
    v_cvt_pk_bf16_f32 v78, v80, v81
    v_cvt_pk_bf16_f32 v79, v82, v83
    v_exp_f32 v84, v84
    v_exp_f32 v85, v85
    v_mfma_f32_32x32x16_bf16 v[92:107], v[36:39], v[76:79], v[92:107]
    v_exp_f32 v86, v86
    v_exp_f32 v87, v87
    v_exp_f32 v88, v88
    v_exp_f32 v89, v89
    v_exp_f32 v90, v90
    v_exp_f32 v91, v91
    v_cvt_pk_bf16_f32 v84, v84, v85
    v_cvt_pk_bf16_f32 v85, v86, v87
    v_cvt_pk_bf16_f32 v86, v88, v89
    v_cvt_pk_bf16_f32 v87, v90, v91
    s_nop 1
    v_mfma_f32_32x32x16_bf16 v[92:107], v[40:43], v[84:87], v[92:107]
    s_waitcnt lgkmcnt(0)
    ds_read_b128 v[12:15], v47 offset:6144
    ds_read_b64 v[20:21], v48 offset:1536
    ds_read_b128 v[36:39], v49 offset:6720
    ds_read_b128 v[40:43], v49 offset:7392
    v_mfma_f32_32x32x16_bf16 v[76:91], v[16:19], v[4:7], 0
    v_mfma_f32_32x32x16_bf16 v[76:91], v[24:27], v[8:11], v[76:91]
    v_exp_f32 v60, v60
    v_exp_f32 v61, v61
    v_exp_f32 v62, v62
    v_exp_f32 v63, v63
    v_exp_f32 v64, v64
    v_exp_f32 v65, v65
    v_exp_f32 v66, v66
    v_exp_f32 v67, v67
    v_cvt_pk_bf16_f32 v60, v60, v61
    v_cvt_pk_bf16_f32 v61, v62, v63
    v_cvt_pk_bf16_f32 v62, v64, v65
    v_cvt_pk_bf16_f32 v63, v66, v67
    v_exp_f32 v68, v68
    v_exp_f32 v69, v69
    v_mfma_f32_32x32x16_bf16 v[92:107], v[28:31], v[60:63], v[92:107]
    v_exp_f32 v70, v70
    v_exp_f32 v71, v71
    v_exp_f32 v72, v72
    v_exp_f32 v73, v73
    v_exp_f32 v74, v74
    v_exp_f32 v75, v75
    v_cvt_pk_bf16_f32 v68, v68, v69
    v_cvt_pk_bf16_f32 v69, v70, v71
    v_cvt_pk_bf16_f32 v70, v72, v73
    v_cvt_pk_bf16_f32 v71, v74, v75
    s_nop 1
    v_mfma_f32_32x32x16_bf16 v[92:107], v[32:35], v[68:71], v[92:107]
    s_waitcnt lgkmcnt(0)
    ds_read_b128 v[16:19], v47 offset:7168
    ds_read_b64 v[24:25], v48 offset:1792
    ds_read_b128 v[28:31], v49 offset:8064
    ds_read_b128 v[32:35], v49 offset:8736
    v_mfma_f32_32x32x16_bf16 v[60:75], v[12:15], v[4:7], 0
    v_mfma_f32_32x32x16_bf16 v[60:75], v[20:23], v[8:11], v[60:75]
    v_exp_f32 v76, v76
    v_exp_f32 v77, v77
    v_exp_f32 v78, v78
    v_exp_f32 v79, v79
    v_exp_f32 v80, v80
    v_exp_f32 v81, v81
    v_exp_f32 v82, v82
    v_exp_f32 v83, v83
    v_cvt_pk_bf16_f32 v76, v76, v77
    v_cvt_pk_bf16_f32 v77, v78, v79
    v_cvt_pk_bf16_f32 v78, v80, v81
    v_cvt_pk_bf16_f32 v79, v82, v83
    v_exp_f32 v84, v84
    v_exp_f32 v85, v85
    v_mfma_f32_32x32x16_bf16 v[92:107], v[36:39], v[76:79], v[92:107]
    v_exp_f32 v86, v86
    v_exp_f32 v87, v87
    v_exp_f32 v88, v88
    v_exp_f32 v89, v89
    v_exp_f32 v90, v90
    v_exp_f32 v91, v91
    v_cvt_pk_bf16_f32 v84, v84, v85
    v_cvt_pk_bf16_f32 v85, v86, v87
    v_cvt_pk_bf16_f32 v86, v88, v89
    v_cvt_pk_bf16_f32 v87, v90, v91
    s_nop 1
    v_mfma_f32_32x32x16_bf16 v[92:107], v[40:43], v[84:87], v[92:107]
    s_waitcnt lgkmcnt(0)
    ds_read_b128 v[12:15], v50 offset:0
    ds_read_b64 v[20:21], v51 offset:0
    ds_read_b128 v[36:39], v49 offset:9408
    ds_read_b128 v[40:43], v49 offset:10080
    v_mfma_f32_32x32x16_bf16 v[76:91], v[16:19], v[4:7], 0
    v_mfma_f32_32x32x16_bf16 v[76:91], v[24:27], v[8:11], v[76:91]
    v_exp_f32 v60, v60
    v_exp_f32 v61, v61
    v_exp_f32 v62, v62
    v_exp_f32 v63, v63
    v_exp_f32 v64, v64
    v_exp_f32 v65, v65
    v_exp_f32 v66, v66
    v_exp_f32 v67, v67
    v_cvt_pk_bf16_f32 v60, v60, v61
    v_cvt_pk_bf16_f32 v61, v62, v63
    v_cvt_pk_bf16_f32 v62, v64, v65
    v_cvt_pk_bf16_f32 v63, v66, v67
    v_exp_f32 v68, v68
    v_exp_f32 v69, v69
    v_mfma_f32_32x32x16_bf16 v[92:107], v[28:31], v[60:63], v[92:107]
    v_exp_f32 v70, v70
    v_exp_f32 v71, v71
    v_exp_f32 v72, v72
    v_exp_f32 v73, v73
    v_exp_f32 v74, v74
    v_exp_f32 v75, v75
    v_cvt_pk_bf16_f32 v68, v68, v69
    v_cvt_pk_bf16_f32 v69, v70, v71
    v_cvt_pk_bf16_f32 v70, v72, v73
    v_cvt_pk_bf16_f32 v71, v74, v75
    s_nop 1
    v_mfma_f32_32x32x16_bf16 v[92:107], v[32:35], v[68:71], v[92:107]
    s_waitcnt lgkmcnt(0)
    ds_read_b128 v[16:19], v50 offset:1024
    ds_read_b64 v[24:25], v51 offset:256
    ds_read_b128 v[28:31], v52 offset:0
    ds_read_b128 v[32:35], v52 offset:672
    v_mfma_f32_32x32x16_bf16 v[60:75], v[12:15], v[4:7], 0
    v_mfma_f32_32x32x16_bf16 v[60:75], v[20:23], v[8:11], v[60:75]
    v_exp_f32 v76, v76
    v_exp_f32 v77, v77
    v_exp_f32 v78, v78
    v_exp_f32 v79, v79
    v_exp_f32 v80, v80
    v_exp_f32 v81, v81
    v_exp_f32 v82, v82
    v_exp_f32 v83, v83
    v_cvt_pk_bf16_f32 v76, v76, v77
    v_cvt_pk_bf16_f32 v77, v78, v79
    v_cvt_pk_bf16_f32 v78, v80, v81
    v_cvt_pk_bf16_f32 v79, v82, v83
    v_exp_f32 v84, v84
    v_exp_f32 v85, v85
    v_mfma_f32_32x32x16_bf16 v[92:107], v[36:39], v[76:79], v[92:107]
    v_exp_f32 v86, v86
    v_exp_f32 v87, v87
    v_exp_f32 v88, v88
    v_exp_f32 v89, v89
    v_exp_f32 v90, v90
    v_exp_f32 v91, v91
    v_cvt_pk_bf16_f32 v84, v84, v85
    v_cvt_pk_bf16_f32 v85, v86, v87
    v_cvt_pk_bf16_f32 v86, v88, v89
    v_cvt_pk_bf16_f32 v87, v90, v91
    s_nop 1
    v_mfma_f32_32x32x16_bf16 v[92:107], v[40:43], v[84:87], v[92:107]
    s_nop 15
    v_cmp_nle_f32 vcc, v100, s48
    s_and_b64 vcc, vcc, s[54:55]
    s_cbranch_scc0 A_next
    v_mov_b32 v92, v108
    v_mov_b32 v93, v109
    v_mov_b32 v94, v110
    v_mov_b32 v95, v111
    v_mov_b32 v96, v112
    v_mov_b32 v97, v113
    v_mov_b32 v98, v114
    v_mov_b32 v99, v115
    v_mov_b32 v100, v116
    v_mov_b32 v101, v117
    v_mov_b32 v102, v118
    v_mov_b32 v103, v119
    s_waitcnt lgkmcnt(0)
    ds_read_b128 v[12:15], v47 offset:0
    ds_read_b64 v[20:21], v48 offset:0
    ds_read_b128 v[16:19], v47 offset:1024
    ds_read_b64 v[24:25], v48 offset:256
    ds_read_b128 v[28:31], v49 offset:0
    ds_read_b128 v[32:35], v49 offset:672
    s_waitcnt lgkmcnt(0)
    v_mfma_f32_32x32x16_bf16 v[60:75], v[12:15], v[4:7], 0
    v_mfma_f32_32x32x16_bf16 v[60:75], v[20:23], v[8:11], v[60:75]
    s_nop 7
    s_nop 7
    s_waitcnt lgkmcnt(0)
    ds_read_b128 v[12:15], v47 offset:2048
    ds_read_b64 v[20:21], v48 offset:512
    ds_read_b128 v[36:39], v49 offset:1344
    ds_read_b128 v[40:43], v49 offset:2016
    v_mfma_f32_32x32x16_bf16 v[76:91], v[16:19], v[4:7], 0
    v_mfma_f32_32x32x16_bf16 v[76:91], v[24:27], v[8:11], v[76:91]
    v_max3_f32 v123, v60, v61, v62
    v_max3_f32 v123, v123, v63, v64
    v_max3_f32 v123, v123, v65, v66
    v_max3_f32 v123, v123, v67, v68
    v_max3_f32 v123, v123, v69, v70
    v_max3_f32 v123, v123, v71, v72
    v_max3_f32 v123, v123, v73, v74
    v_max_f32 v123, v123, v75
    v_cmp_lt_f32 vcc, s45, v123
    s_cbranch_vccnz A_rare0
A_back0:
    v_exp_f32 v60, v60
    v_exp_f32 v61, v61
    v_exp_f32 v62, v62
    v_exp_f32 v63, v63
    v_exp_f32 v64, v64
    v_exp_f32 v65, v65
    v_exp_f32 v66, v66
    v_exp_f32 v67, v67
    v_cvt_pk_bf16_f32 v60, v60, v61
    v_cvt_pk_bf16_f32 v61, v62, v63
    v_cvt_pk_bf16_f32 v62, v64, v65
    v_cvt_pk_bf16_f32 v63, v66, v67
    v_exp_f32 v68, v68
    v_exp_f32 v69, v69
    v_mfma_f32_32x32x16_bf16 v[92:107], v[28:31], v[60:63], v[92:107]
    v_exp_f32 v70, v70
    v_exp_f32 v71, v71
    v_exp_f32 v72, v72
    v_exp_f32 v73, v73
    v_exp_f32 v74, v74
    v_exp_f32 v75, v75
    v_cvt_pk_bf16_f32 v68, v68, v69
    v_cvt_pk_bf16_f32 v69, v70, v71
    v_cvt_pk_bf16_f32 v70, v72, v73
    v_cvt_pk_bf16_f32 v71, v74, v75
    s_nop 1
    v_mfma_f32_32x32x16_bf16 v[92:107], v[32:35], v[68:71], v[92:107]
    s_waitcnt lgkmcnt(0)
    ds_read_b128 v[16:19], v47 offset:3072
    ds_read_b64 v[24:25], v48 offset:768
    ds_read_b128 v[28:31], v49 offset:2688
    ds_read_b128 v[32:35], v49 offset:3360
    v_mfma_f32_32x32x16_bf16 v[60:75], v[12:15], v[4:7], 0
    v_mfma_f32_32x32x16_bf16 v[60:75], v[20:23], v[8:11], v[60:75]
    v_max3_f32 v123, v76, v77, v78
    v_max3_f32 v123, v123, v79, v80
    v_max3_f32 v123, v123, v81, v82
    v_max3_f32 v123, v123, v83, v84
    v_max3_f32 v123, v123, v85, v86
    v_max3_f32 v123, v123, v87, v88
    v_max3_f32 v123, v123, v89, v90
    v_max_f32 v123, v123, v91
    v_cmp_lt_f32 vcc, s45, v123
    s_cbranch_vccnz A_rare1
A_back1:
    v_exp_f32 v76, v76
    v_exp_f32 v77, v77
    v_exp_f32 v78, v78
    v_exp_f32 v79, v79
    v_exp_f32 v80, v80
    v_exp_f32 v81, v81
    v_exp_f32 v82, v82
    v_exp_f32 v83, v83
    v_cvt_pk_bf16_f32 v76, v76, v77
    v_cvt_pk_bf16_f32 v77, v78, v79
    v_cvt_pk_bf16_f32 v78, v80, v81
    v_cvt_pk_bf16_f32 v79, v82, v83
    v_exp_f32 v84, v84
    v_exp_f32 v85, v85
    v_mfma_f32_32x32x16_bf16 v[92:107], v[36:39], v[76:79], v[92:107]
    v_exp_f32 v86, v86
    v_exp_f32 v87, v87
    v_exp_f32 v88, v88
    v_exp_f32 v89, v89
    v_exp_f32 v90, v90
    v_exp_f32 v91, v91
    v_cvt_pk_bf16_f32 v84, v84, v85
    v_cvt_pk_bf16_f32 v85, v86, v87
    v_cvt_pk_bf16_f32 v86, v88, v89
    v_cvt_pk_bf16_f32 v87, v90, v91
    s_nop 1
    v_mfma_f32_32x32x16_bf16 v[92:107], v[40:43], v[84:87], v[92:107]
    s_waitcnt lgkmcnt(0)
    ds_read_b128 v[12:15], v47 offset:4096
    ds_read_b64 v[20:21], v48 offset:1024
    ds_read_b128 v[36:39], v49 offset:4032
    ds_read_b128 v[40:43], v49 offset:4704
    v_mfma_f32_32x32x16_bf16 v[76:91], v[16:19], v[4:7], 0
    v_mfma_f32_32x32x16_bf16 v[76:91], v[24:27], v[8:11], v[76:91]
    v_max3_f32 v123, v60, v61, v62
    v_max3_f32 v123, v123, v63, v64
    v_max3_f32 v123, v123, v65, v66
    v_max3_f32 v123, v123, v67, v68
    v_max3_f32 v123, v123, v69, v70
    v_max3_f32 v123, v123, v71, v72
    v_max3_f32 v123, v123, v73, v74
    v_max_f32 v123, v123, v75
    v_cmp_lt_f32 vcc, s45, v123
    s_cbranch_vccnz A_rare2
A_back2:
    v_exp_f32 v60, v60
    v_exp_f32 v61, v61
    v_exp_f32 v62, v62
    v_exp_f32 v63, v63
    v_exp_f32 v64, v64
    v_exp_f32 v65, v65
    v_exp_f32 v66, v66
    v_exp_f32 v67, v67
    v_cvt_pk_bf16_f32 v60, v60, v61
    v_cvt_pk_bf16_f32 v61, v62, v63
    v_cvt_pk_bf16_f32 v62, v64, v65
    v_cvt_pk_bf16_f32 v63, v66, v67
    v_exp_f32 v68, v68
    v_exp_f32 v69, v69
    v_mfma_f32_32x32x16_bf16 v[92:107], v[28:31], v[60:63], v[92:107]
    v_exp_f32 v70, v70
    v_exp_f32 v71, v71
    v_exp_f32 v72, v72
    v_exp_f32 v73, v73
    v_exp_f32 v74, v74
    v_exp_f32 v75, v75
    v_cvt_pk_bf16_f32 v68, v68, v69
    v_cvt_pk_bf16_f32 v69, v70, v71
    v_cvt_pk_bf16_f32 v70, v72, v73
    v_cvt_pk_bf16_f32 v71, v74, v75
    s_nop 1
    v_mfma_f32_32x32x16_bf16 v[92:107], v[32:35], v[68:71], v[92:107]
    s_waitcnt lgkmcnt(0)
    ds_read_b128 v[16:19], v47 offset:5120
    ds_read_b64 v[24:25], v48 offset:1280
    ds_read_b128 v[28:31], v49 offset:5376
    ds_read_b128 v[32:35], v49 offset:6048
    v_mfma_f32_32x32x16_bf16 v[60:75], v[12:15], v[4:7], 0
    v_mfma_f32_32x32x16_bf16 v[60:75], v[20:23], v[8:11], v[60:75]
    v_max3_f32 v123, v76, v77, v78
    v_max3_f32 v123, v123, v79, v80
    v_max3_f32 v123, v123, v81, v82
    v_max3_f32 v123, v123, v83, v84
    v_max3_f32 v123, v123, v85, v86
    v_max3_f32 v123, v123, v87, v88
    v_max3_f32 v123, v123, v89, v90
    v_max_f32 v123, v123, v91
    v_cmp_lt_f32 vcc, s45, v123
    s_cbranch_vccnz A_rare3
A_back3:
    v_exp_f32 v76, v76
    v_exp_f32 v77, v77
    v_exp_f32 v78, v78
    v_exp_f32 v79, v79
    v_exp_f32 v80, v80
    v_exp_f32 v81, v81
    v_exp_f32 v82, v82
    v_exp_f32 v83, v83
    v_cvt_pk_bf16_f32 v76, v76, v77
    v_cvt_pk_bf16_f32 v77, v78, v79
    v_cvt_pk_bf16_f32 v78, v80, v81
    v_cvt_pk_bf16_f32 v79, v82, v83
    v_exp_f32 v84, v84
    v_exp_f32 v85, v85
    v_mfma_f32_32x32x16_bf16 v[92:107], v[36:39], v[76:79], v[92:107]
    v_exp_f32 v86, v86
    v_exp_f32 v87, v87
    v_exp_f32 v88, v88
    v_exp_f32 v89, v89
    v_exp_f32 v90, v90
    v_exp_f32 v91, v91
    v_cvt_pk_bf16_f32 v84, v84, v85
    v_cvt_pk_bf16_f32 v85, v86, v87
    v_cvt_pk_bf16_f32 v86, v88, v89
    v_cvt_pk_bf16_f32 v87, v90, v91
    s_nop 1
    v_mfma_f32_32x32x16_bf16 v[92:107], v[40:43], v[84:87], v[92:107]
    s_waitcnt lgkmcnt(0)
    ds_read_b128 v[12:15], v47 offset:6144
    ds_read_b64 v[20:21], v48 offset:1536
    ds_read_b128 v[36:39], v49 offset:6720
    ds_read_b128 v[40:43], v49 offset:7392
    v_mfma_f32_32x32x16_bf16 v[76:91], v[16:19], v[4:7], 0
    v_mfma_f32_32x32x16_bf16 v[76:91], v[24:27], v[8:11], v[76:91]
    v_max3_f32 v123, v60, v61, v62
    v_max3_f32 v123, v123, v63, v64
    v_max3_f32 v123, v123, v65, v66
    v_max3_f32 v123, v123, v67, v68
    v_max3_f32 v123, v123, v69, v70
    v_max3_f32 v123, v123, v71, v72
    v_max3_f32 v123, v123, v73, v74
    v_max_f32 v123, v123, v75
    v_cmp_lt_f32 vcc, s45, v123
    s_cbranch_vccnz A_rare4
A_back4:
    v_exp_f32 v60, v60
    v_exp_f32 v61, v61
    v_exp_f32 v62, v62
    v_exp_f32 v63, v63
    v_exp_f32 v64, v64
    v_exp_f32 v65, v65
    v_exp_f32 v66, v66
    v_exp_f32 v67, v67
    v_cvt_pk_bf16_f32 v60, v60, v61
    v_cvt_pk_bf16_f32 v61, v62, v63
    v_cvt_pk_bf16_f32 v62, v64, v65
    v_cvt_pk_bf16_f32 v63, v66, v67
    v_exp_f32 v68, v68
    v_exp_f32 v69, v69
    v_mfma_f32_32x32x16_bf16 v[92:107], v[28:31], v[60:63], v[92:107]
    v_exp_f32 v70, v70
    v_exp_f32 v71, v71
    v_exp_f32 v72, v72
    v_exp_f32 v73, v73
    v_exp_f32 v74, v74
    v_exp_f32 v75, v75
    v_cvt_pk_bf16_f32 v68, v68, v69
    v_cvt_pk_bf16_f32 v69, v70, v71
    v_cvt_pk_bf16_f32 v70, v72, v73
    v_cvt_pk_bf16_f32 v71, v74, v75
    s_nop 1
    v_mfma_f32_32x32x16_bf16 v[92:107], v[32:35], v[68:71], v[92:107]
    s_waitcnt lgkmcnt(0)
    ds_read_b128 v[16:19], v47 offset:7168
    ds_read_b64 v[24:25], v48 offset:1792
    ds_read_b128 v[28:31], v49 offset:8064
    ds_read_b128 v[32:35], v49 offset:8736
    v_mfma_f32_32x32x16_bf16 v[60:75], v[12:15], v[4:7], 0
    v_mfma_f32_32x32x16_bf16 v[60:75], v[20:23], v[8:11], v[60:75]
    v_max3_f32 v123, v76, v77, v78
    v_max3_f32 v123, v123, v79, v80
    v_max3_f32 v123, v123, v81, v82
    v_max3_f32 v123, v123, v83, v84
    v_max3_f32 v123, v123, v85, v86
    v_max3_f32 v123, v123, v87, v88
    v_max3_f32 v123, v123, v89, v90
    v_max_f32 v123, v123, v91
    v_cmp_lt_f32 vcc, s45, v123
    s_cbranch_vccnz A_rare5
A_back5:
    v_exp_f32 v76, v76
    v_exp_f32 v77, v77
    v_exp_f32 v78, v78
    v_exp_f32 v79, v79
    v_exp_f32 v80, v80
    v_exp_f32 v81, v81
    v_exp_f32 v82, v82
    v_exp_f32 v83, v83
    v_cvt_pk_bf16_f32 v76, v76, v77
    v_cvt_pk_bf16_f32 v77, v78, v79
    v_cvt_pk_bf16_f32 v78, v80, v81
    v_cvt_pk_bf16_f32 v79, v82, v83
    v_exp_f32 v84, v84
    v_exp_f32 v85, v85
    v_mfma_f32_32x32x16_bf16 v[92:107], v[36:39], v[76:79], v[92:107]
    v_exp_f32 v86, v86
    v_exp_f32 v87, v87
    v_exp_f32 v88, v88
    v_exp_f32 v89, v89
    v_exp_f32 v90, v90
    v_exp_f32 v91, v91
    v_cvt_pk_bf16_f32 v84, v84, v85
    v_cvt_pk_bf16_f32 v85, v86, v87
    v_cvt_pk_bf16_f32 v86, v88, v89
    v_cvt_pk_bf16_f32 v87, v90, v91
    s_nop 1
    v_mfma_f32_32x32x16_bf16 v[92:107], v[40:43], v[84:87], v[92:107]
    s_waitcnt lgkmcnt(0)
    ds_read_b128 v[12:15], v50 offset:0
    ds_read_b64 v[20:21], v51 offset:0
    ds_read_b128 v[36:39], v49 offset:9408
    ds_read_b128 v[40:43], v49 offset:10080
    v_mfma_f32_32x32x16_bf16 v[76:91], v[16:19], v[4:7], 0
    v_mfma_f32_32x32x16_bf16 v[76:91], v[24:27], v[8:11], v[76:91]
    v_max3_f32 v123, v60, v61, v62
    v_max3_f32 v123, v123, v63, v64
    v_max3_f32 v123, v123, v65, v66
    v_max3_f32 v123, v123, v67, v68
    v_max3_f32 v123, v123, v69, v70
    v_max3_f32 v123, v123, v71, v72
    v_max3_f32 v123, v123, v73, v74
    v_max_f32 v123, v123, v75
    v_cmp_lt_f32 vcc, s45, v123
    s_cbranch_vccnz A_rare6
A_back6:
    v_exp_f32 v60, v60
    v_exp_f32 v61, v61
    v_exp_f32 v62, v62
    v_exp_f32 v63, v63
    v_exp_f32 v64, v64
    v_exp_f32 v65, v65
    v_exp_f32 v66, v66
    v_exp_f32 v67, v67
    v_cvt_pk_bf16_f32 v60, v60, v61
    v_cvt_pk_bf16_f32 v61, v62, v63
    v_cvt_pk_bf16_f32 v62, v64, v65
    v_cvt_pk_bf16_f32 v63, v66, v67
    v_exp_f32 v68, v68
    v_exp_f32 v69, v69
    v_mfma_f32_32x32x16_bf16 v[92:107], v[28:31], v[60:63], v[92:107]
    v_exp_f32 v70, v70
    v_exp_f32 v71, v71
    v_exp_f32 v72, v72
    v_exp_f32 v73, v73
    v_exp_f32 v74, v74
    v_exp_f32 v75, v75
    v_cvt_pk_bf16_f32 v68, v68, v69
    v_cvt_pk_bf16_f32 v69, v70, v71
    v_cvt_pk_bf16_f32 v70, v72, v73
    v_cvt_pk_bf16_f32 v71, v74, v75
    s_nop 1
    v_mfma_f32_32x32x16_bf16 v[92:107], v[32:35], v[68:71], v[92:107]
    s_waitcnt lgkmcnt(0)
    ds_read_b128 v[16:19], v50 offset:1024
    ds_read_b64 v[24:25], v51 offset:256
    ds_read_b128 v[28:31], v52 offset:0
    ds_read_b128 v[32:35], v52 offset:672
    v_mfma_f32_32x32x16_bf16 v[60:75], v[12:15], v[4:7], 0
    v_mfma_f32_32x32x16_bf16 v[60:75], v[20:23], v[8:11], v[60:75]
    v_max3_f32 v123, v76, v77, v78
    v_max3_f32 v123, v123, v79, v80
    v_max3_f32 v123, v123, v81, v82
    v_max3_f32 v123, v123, v83, v84
    v_max3_f32 v123, v123, v85, v86
    v_max3_f32 v123, v123, v87, v88
    v_max3_f32 v123, v123, v89, v90
    v_max_f32 v123, v123, v91
    v_cmp_lt_f32 vcc, s45, v123
    s_cbranch_vccnz A_rare7
A_back7:
    v_exp_f32 v76, v76
    v_exp_f32 v77, v77
    v_exp_f32 v78, v78
    v_exp_f32 v79, v79
    v_exp_f32 v80, v80
    v_exp_f32 v81, v81
    v_exp_f32 v82, v82
    v_exp_f32 v83, v83
    v_cvt_pk_bf16_f32 v76, v76, v77
    v_cvt_pk_bf16_f32 v77, v78, v79
    v_cvt_pk_bf16_f32 v78, v80, v81
    v_cvt_pk_bf16_f32 v79, v82, v83
    v_exp_f32 v84, v84
    v_exp_f32 v85, v85
    v_mfma_f32_32x32x16_bf16 v[92:107], v[36:39], v[76:79], v[92:107]
    v_exp_f32 v86, v86
    v_exp_f32 v87, v87
    v_exp_f32 v88, v88
    v_exp_f32 v89, v89
    v_exp_f32 v90, v90
    v_exp_f32 v91, v91
    v_cvt_pk_bf16_f32 v84, v84, v85
    v_cvt_pk_bf16_f32 v85, v86, v87
    v_cvt_pk_bf16_f32 v86, v88, v89
    v_cvt_pk_bf16_f32 v87, v90, v91
    s_nop 1
    v_mfma_f32_32x32x16_bf16 v[92:107], v[40:43], v[84:87], v[92:107]
A_next:
    s_add_u32 s56, s56, 21504
    s_cmp_eq_u32 s56, 64512
    s_cselect_b32 s56, 0, s56
    s_add_u32 s57, s56, 21504
    s_cmp_eq_u32 s57, 64512
    s_cselect_b32 s57, 0, s57
    v_add_u32 v47, s56, v44
    v_add_u32 v50, s57, v44
    v_add_u32 v48, s56, v45
    v_add_u32 v51, s57, v45
    v_add_u32 v49, s56, v46
    v_add_u32 v52, s57, v46
    s_add_u32 s44, s44, 1
    s_cmp_lt_u32 s44, 8
    s_cbranch_scc1 A_loop
    s_nop 7
    v_mov_b32 v125, v100
    v_mov_b32 v126, v100
    s_nop 1
    v_permlane32_swap_b32 v125, v126
    s_nop 1
    v_rcp_f32 v126, v126
    s_nop 0
    v_mul_f32 v92, v92, v126
    v_mul_f32 v93, v93, v126
    v_mul_f32 v94, v94, v126
    v_mul_f32 v95, v95, v126
    v_mul_f32 v96, v96, v126
    v_mul_f32 v97, v97, v126
    v_mul_f32 v98, v98, v126
    v_mul_f32 v99, v99, v126
    v_mul_f32 v100, v100, v126
    v_mul_f32 v101, v101, v126
    v_mul_f32 v102, v102, v126
    v_mul_f32 v103, v103, v126
    v_cvt_pk_bf16_f32 v60, v92, v93
    v_cvt_pk_bf16_f32 v61, v94, v95
    v_cvt_pk_bf16_f32 v62, v96, v97
    v_cvt_pk_bf16_f32 v63, v98, v99
    v_cvt_pk_bf16_f32 v64, v100, v101
    v_cvt_pk_bf16_f32 v65, v102, v103
    v_mul_u32_u24 v4, 40, v2
    v_lshl_add_u32 v4, v3, 3, v4
    s_add_u32 s42, s41, 5439488
    buffer_store_dwordx2 v[60:61], v4, s[24:27], s42 offen
    buffer_store_dwordx2 v[62:63], v4, s[24:27], s42 offen offset:16
    s_mov_b64 exec, s[52:53]
    buffer_store_dwordx2 v[64:65], v4, s[24:27], s42 offen offset:32
    s_mov_b64 exec, -1
    s_endpgm
A_rare0:
    v_mov_b32 v125, v123
    s_nop 1
    v_permlane32_swap_b32 v125, v123
    s_nop 1
    v_max_f32 v123, v123, v125
    v_max_f32 v123, 0, v123
    v_sub_f32 v60, v60, v123
    v_sub_f32 v61, v61, v123
    v_sub_f32 v62, v62, v123
    v_sub_f32 v63, v63, v123
    v_sub_f32 v64, v64, v123
    v_sub_f32 v65, v65, v123
    v_sub_f32 v66, v66, v123
    v_sub_f32 v67, v67, v123
    v_sub_f32 v68, v68, v123
    v_sub_f32 v69, v69, v123
    v_sub_f32 v70, v70, v123
    v_sub_f32 v71, v71, v123
    v_sub_f32 v72, v72, v123
    v_sub_f32 v73, v73, v123
    v_sub_f32 v74, v74, v123
    v_sub_f32 v75, v75, v123
    s_nop 7
    v_sub_f32 v76, v76, v123
    v_sub_f32 v77, v77, v123
    v_sub_f32 v78, v78, v123
    v_sub_f32 v79, v79, v123
    v_sub_f32 v80, v80, v123
    v_sub_f32 v81, v81, v123
    v_sub_f32 v82, v82, v123
    v_sub_f32 v83, v83, v123
    v_sub_f32 v84, v84, v123
    v_sub_f32 v85, v85, v123
    v_sub_f32 v86, v86, v123
    v_sub_f32 v87, v87, v123
    v_sub_f32 v88, v88, v123
    v_sub_f32 v89, v89, v123
    v_sub_f32 v90, v90, v123
    v_sub_f32 v91, v91, v123
    v_exp_f32 v125, -v123
    s_nop 0
    v_mul_f32 v92, v92, v125
    v_mul_f32 v93, v93, v125
    v_mul_f32 v94, v94, v125
    v_mul_f32 v95, v95, v125
    v_mul_f32 v96, v96, v125
    v_mul_f32 v97, v97, v125
    v_mul_f32 v98, v98, v125
    v_mul_f32 v99, v99, v125
    v_mul_f32 v100, v100, v125
    v_mul_f32 v101, v101, v125
    v_mul_f32 v102, v102, v125
    v_mul_f32 v103, v103, v125
    v_mul_f32 v104, v104, v125
    v_mul_f32 v105, v105, v125
    v_mul_f32 v106, v106, v125
    v_mul_f32 v107, v107, v125
    v_sub_f32 v124, v124, v123
    v_cvt_pk_bf16_f32 v125, v124, v124
    v_lshlrev_b32 v125, 16, v125
    v_sub_f32 v126, v124, v125
    v_cvt_pk_bf16_f32 v125, v126, v126
    v_lshlrev_b32 v125, 16, v125
    v_sub_f32 v125, v126, v125
    s_mov_b64 exec, s[52:53]
    v_cvt_pk_bf16_f32 v10, v124, v126
    v_cvt_pk_bf16_f32 v11, v125, 0
    s_mov_b64 exec, -1
    s_nop 1
    s_branch A_back0
A_rare1:
    v_mov_b32 v125, v123
    s_nop 1
    v_permlane32_swap_b32 v125, v123
    s_nop 1
    v_max_f32 v123, v123, v125
    v_max_f32 v123, 0, v123
    v_sub_f32 v76, v76, v123
    v_sub_f32 v77, v77, v123
    v_sub_f32 v78, v78, v123
    v_sub_f32 v79, v79, v123
    v_sub_f32 v80, v80, v123
    v_sub_f32 v81, v81, v123
    v_sub_f32 v82, v82, v123
    v_sub_f32 v83, v83, v123
    v_sub_f32 v84, v84, v123
    v_sub_f32 v85, v85, v123
    v_sub_f32 v86, v86, v123
    v_sub_f32 v87, v87, v123
    v_sub_f32 v88, v88, v123
    v_sub_f32 v89, v89, v123
    v_sub_f32 v90, v90, v123
    v_sub_f32 v91, v91, v123
    s_nop 7
    v_sub_f32 v60, v60, v123
    v_sub_f32 v61, v61, v123
    v_sub_f32 v62, v62, v123
    v_sub_f32 v63, v63, v123
    v_sub_f32 v64, v64, v123
    v_sub_f32 v65, v65, v123
    v_sub_f32 v66, v66, v123
    v_sub_f32 v67, v67, v123
    v_sub_f32 v68, v68, v123
    v_sub_f32 v69, v69, v123
    v_sub_f32 v70, v70, v123
    v_sub_f32 v71, v71, v123
    v_sub_f32 v72, v72, v123
    v_sub_f32 v73, v73, v123
    v_sub_f32 v74, v74, v123
    v_sub_f32 v75, v75, v123
    v_exp_f32 v125, -v123
    s_nop 0
    v_mul_f32 v92, v92, v125
    v_mul_f32 v93, v93, v125
    v_mul_f32 v94, v94, v125
    v_mul_f32 v95, v95, v125
    v_mul_f32 v96, v96, v125
    v_mul_f32 v97, v97, v125
    v_mul_f32 v98, v98, v125
    v_mul_f32 v99, v99, v125
    v_mul_f32 v100, v100, v125
    v_mul_f32 v101, v101, v125
    v_mul_f32 v102, v102, v125
    v_mul_f32 v103, v103, v125
    v_mul_f32 v104, v104, v125
    v_mul_f32 v105, v105, v125
    v_mul_f32 v106, v106, v125
    v_mul_f32 v107, v107, v125
    v_sub_f32 v124, v124, v123
    v_cvt_pk_bf16_f32 v125, v124, v124
    v_lshlrev_b32 v125, 16, v125
    v_sub_f32 v126, v124, v125
    v_cvt_pk_bf16_f32 v125, v126, v126
    v_lshlrev_b32 v125, 16, v125
    v_sub_f32 v125, v126, v125
    s_mov_b64 exec, s[52:53]
    v_cvt_pk_bf16_f32 v10, v124, v126
    v_cvt_pk_bf16_f32 v11, v125, 0
    s_mov_b64 exec, -1
    s_nop 1
    s_branch A_back1
A_rare2:
    v_mov_b32 v125, v123
    s_nop 1
    v_permlane32_swap_b32 v125, v123
    s_nop 1
    v_max_f32 v123, v123, v125
    v_max_f32 v123, 0, v123
    v_sub_f32 v60, v60, v123
    v_sub_f32 v61, v61, v123
    v_sub_f32 v62, v62, v123
    v_sub_f32 v63, v63, v123
    v_sub_f32 v64, v64, v123
    v_sub_f32 v65, v65, v123
    v_sub_f32 v66, v66, v123
    v_sub_f32 v67, v67, v123
    v_sub_f32 v68, v68, v123
    v_sub_f32 v69, v69, v123
    v_sub_f32 v70, v70, v123
    v_sub_f32 v71, v71, v123
    v_sub_f32 v72, v72, v123
    v_sub_f32 v73, v73, v123
    v_sub_f32 v74, v74, v123
    v_sub_f32 v75, v75, v123
    s_nop 7
    v_sub_f32 v76, v76, v123
    v_sub_f32 v77, v77, v123
    v_sub_f32 v78, v78, v123
    v_sub_f32 v79, v79, v123
    v_sub_f32 v80, v80, v123
    v_sub_f32 v81, v81, v123
    v_sub_f32 v82, v82, v123
    v_sub_f32 v83, v83, v123
    v_sub_f32 v84, v84, v123
    v_sub_f32 v85, v85, v123
    v_sub_f32 v86, v86, v123
    v_sub_f32 v87, v87, v123
    v_sub_f32 v88, v88, v123
    v_sub_f32 v89, v89, v123
    v_sub_f32 v90, v90, v123
    v_sub_f32 v91, v91, v123
    v_exp_f32 v125, -v123
    s_nop 0
    v_mul_f32 v92, v92, v125
    v_mul_f32 v93, v93, v125
    v_mul_f32 v94, v94, v125
    v_mul_f32 v95, v95, v125
    v_mul_f32 v96, v96, v125
    v_mul_f32 v97, v97, v125
    v_mul_f32 v98, v98, v125
    v_mul_f32 v99, v99, v125
    v_mul_f32 v100, v100, v125
    v_mul_f32 v101, v101, v125
    v_mul_f32 v102, v102, v125
    v_mul_f32 v103, v103, v125
    v_mul_f32 v104, v104, v125
    v_mul_f32 v105, v105, v125
    v_mul_f32 v106, v106, v125
    v_mul_f32 v107, v107, v125
    v_sub_f32 v124, v124, v123
    v_cvt_pk_bf16_f32 v125, v124, v124
    v_lshlrev_b32 v125, 16, v125
    v_sub_f32 v126, v124, v125
    v_cvt_pk_bf16_f32 v125, v126, v126
    v_lshlrev_b32 v125, 16, v125
    v_sub_f32 v125, v126, v125
    s_mov_b64 exec, s[52:53]
    v_cvt_pk_bf16_f32 v10, v124, v126
    v_cvt_pk_bf16_f32 v11, v125, 0
    s_mov_b64 exec, -1
    s_nop 1
    s_branch A_back2
A_rare3:
    v_mov_b32 v125, v123
    s_nop 1
    v_permlane32_swap_b32 v125, v123
    s_nop 1
    v_max_f32 v123, v123, v125
    v_max_f32 v123, 0, v123
    v_sub_f32 v76, v76, v123
    v_sub_f32 v77, v77, v123
    v_sub_f32 v78, v78, v123
    v_sub_f32 v79, v79, v123
    v_sub_f32 v80, v80, v123
    v_sub_f32 v81, v81, v123
    v_sub_f32 v82, v82, v123
    v_sub_f32 v83, v83, v123
    v_sub_f32 v84, v84, v123
    v_sub_f32 v85, v85, v123
    v_sub_f32 v86, v86, v123
    v_sub_f32 v87, v87, v123
    v_sub_f32 v88, v88, v123
    v_sub_f32 v89, v89, v123
    v_sub_f32 v90, v90, v123
    v_sub_f32 v91, v91, v123
    s_nop 7
    v_sub_f32 v60, v60, v123
    v_sub_f32 v61, v61, v123
    v_sub_f32 v62, v62, v123
    v_sub_f32 v63, v63, v123
    v_sub_f32 v64, v64, v123
    v_sub_f32 v65, v65, v123
    v_sub_f32 v66, v66, v123
    v_sub_f32 v67, v67, v123
    v_sub_f32 v68, v68, v123
    v_sub_f32 v69, v69, v123
    v_sub_f32 v70, v70, v123
    v_sub_f32 v71, v71, v123
    v_sub_f32 v72, v72, v123
    v_sub_f32 v73, v73, v123
    v_sub_f32 v74, v74, v123
    v_sub_f32 v75, v75, v123
    v_exp_f32 v125, -v123
    s_nop 0
    v_mul_f32 v92, v92, v125
    v_mul_f32 v93, v93, v125
    v_mul_f32 v94, v94, v125
    v_mul_f32 v95, v95, v125
    v_mul_f32 v96, v96, v125
    v_mul_f32 v97, v97, v125
    v_mul_f32 v98, v98, v125
    v_mul_f32 v99, v99, v125
    v_mul_f32 v100, v100, v125
    v_mul_f32 v101, v101, v125
    v_mul_f32 v102, v102, v125
    v_mul_f32 v103, v103, v125
    v_mul_f32 v104, v104, v125
    v_mul_f32 v105, v105, v125
    v_mul_f32 v106, v106, v125
    v_mul_f32 v107, v107, v125
    v_sub_f32 v124, v124, v123
    v_cvt_pk_bf16_f32 v125, v124, v124
    v_lshlrev_b32 v125, 16, v125
    v_sub_f32 v126, v124, v125
    v_cvt_pk_bf16_f32 v125, v126, v126
    v_lshlrev_b32 v125, 16, v125
    v_sub_f32 v125, v126, v125
    s_mov_b64 exec, s[52:53]
    v_cvt_pk_bf16_f32 v10, v124, v126
    v_cvt_pk_bf16_f32 v11, v125, 0
    s_mov_b64 exec, -1
    s_nop 1
    s_branch A_back3
A_rare4:
    v_mov_b32 v125, v123
    s_nop 1
    v_permlane32_swap_b32 v125, v123
    s_nop 1
    v_max_f32 v123, v123, v125
    v_max_f32 v123, 0, v123
    v_sub_f32 v60, v60, v123
    v_sub_f32 v61, v61, v123
    v_sub_f32 v62, v62, v123
    v_sub_f32 v63, v63, v123
    v_sub_f32 v64, v64, v123
    v_sub_f32 v65, v65, v123
    v_sub_f32 v66, v66, v123
    v_sub_f32 v67, v67, v123
    v_sub_f32 v68, v68, v123
    v_sub_f32 v69, v69, v123
    v_sub_f32 v70, v70, v123
    v_sub_f32 v71, v71, v123
    v_sub_f32 v72, v72, v123
    v_sub_f32 v73, v73, v123
    v_sub_f32 v74, v74, v123
    v_sub_f32 v75, v75, v123
    s_nop 7
    v_sub_f32 v76, v76, v123
    v_sub_f32 v77, v77, v123
    v_sub_f32 v78, v78, v123
    v_sub_f32 v79, v79, v123
    v_sub_f32 v80, v80, v123
    v_sub_f32 v81, v81, v123
    v_sub_f32 v82, v82, v123
    v_sub_f32 v83, v83, v123
    v_sub_f32 v84, v84, v123
    v_sub_f32 v85, v85, v123
    v_sub_f32 v86, v86, v123
    v_sub_f32 v87, v87, v123
    v_sub_f32 v88, v88, v123
    v_sub_f32 v89, v89, v123
    v_sub_f32 v90, v90, v123
    v_sub_f32 v91, v91, v123
    v_exp_f32 v125, -v123
    s_nop 0
    v_mul_f32 v92, v92, v125
    v_mul_f32 v93, v93, v125
    v_mul_f32 v94, v94, v125
    v_mul_f32 v95, v95, v125
    v_mul_f32 v96, v96, v125
    v_mul_f32 v97, v97, v125
    v_mul_f32 v98, v98, v125
    v_mul_f32 v99, v99, v125
    v_mul_f32 v100, v100, v125
    v_mul_f32 v101, v101, v125
    v_mul_f32 v102, v102, v125
    v_mul_f32 v103, v103, v125
    v_mul_f32 v104, v104, v125
    v_mul_f32 v105, v105, v125
    v_mul_f32 v106, v106, v125
    v_mul_f32 v107, v107, v125
    v_sub_f32 v124, v124, v123
    v_cvt_pk_bf16_f32 v125, v124, v124
    v_lshlrev_b32 v125, 16, v125
    v_sub_f32 v126, v124, v125
    v_cvt_pk_bf16_f32 v125, v126, v126
    v_lshlrev_b32 v125, 16, v125
    v_sub_f32 v125, v126, v125
    s_mov_b64 exec, s[52:53]
    v_cvt_pk_bf16_f32 v10, v124, v126
    v_cvt_pk_bf16_f32 v11, v125, 0
    s_mov_b64 exec, -1
    s_nop 1
    s_branch A_back4
A_rare5:
    v_mov_b32 v125, v123
    s_nop 1
    v_permlane32_swap_b32 v125, v123
    s_nop 1
    v_max_f32 v123, v123, v125
    v_max_f32 v123, 0, v123
    v_sub_f32 v76, v76, v123
    v_sub_f32 v77, v77, v123
    v_sub_f32 v78, v78, v123
    v_sub_f32 v79, v79, v123
    v_sub_f32 v80, v80, v123
    v_sub_f32 v81, v81, v123
    v_sub_f32 v82, v82, v123
    v_sub_f32 v83, v83, v123
    v_sub_f32 v84, v84, v123
    v_sub_f32 v85, v85, v123
    v_sub_f32 v86, v86, v123
    v_sub_f32 v87, v87, v123
    v_sub_f32 v88, v88, v123
    v_sub_f32 v89, v89, v123
    v_sub_f32 v90, v90, v123
    v_sub_f32 v91, v91, v123
    s_nop 7
    v_sub_f32 v60, v60, v123
    v_sub_f32 v61, v61, v123
    v_sub_f32 v62, v62, v123
    v_sub_f32 v63, v63, v123
    v_sub_f32 v64, v64, v123
    v_sub_f32 v65, v65, v123
    v_sub_f32 v66, v66, v123
    v_sub_f32 v67, v67, v123
    v_sub_f32 v68, v68, v123
    v_sub_f32 v69, v69, v123
    v_sub_f32 v70, v70, v123
    v_sub_f32 v71, v71, v123
    v_sub_f32 v72, v72, v123
    v_sub_f32 v73, v73, v123
    v_sub_f32 v74, v74, v123
    v_sub_f32 v75, v75, v123
    v_exp_f32 v125, -v123
    s_nop 0
    v_mul_f32 v92, v92, v125
    v_mul_f32 v93, v93, v125
    v_mul_f32 v94, v94, v125
    v_mul_f32 v95, v95, v125
    v_mul_f32 v96, v96, v125
    v_mul_f32 v97, v97, v125
    v_mul_f32 v98, v98, v125
    v_mul_f32 v99, v99, v125
    v_mul_f32 v100, v100, v125
    v_mul_f32 v101, v101, v125
    v_mul_f32 v102, v102, v125
    v_mul_f32 v103, v103, v125
    v_mul_f32 v104, v104, v125
    v_mul_f32 v105, v105, v125
    v_mul_f32 v106, v106, v125
    v_mul_f32 v107, v107, v125
    v_sub_f32 v124, v124, v123
    v_cvt_pk_bf16_f32 v125, v124, v124
    v_lshlrev_b32 v125, 16, v125
    v_sub_f32 v126, v124, v125
    v_cvt_pk_bf16_f32 v125, v126, v126
    v_lshlrev_b32 v125, 16, v125
    v_sub_f32 v125, v126, v125
    s_mov_b64 exec, s[52:53]
    v_cvt_pk_bf16_f32 v10, v124, v126
    v_cvt_pk_bf16_f32 v11, v125, 0
    s_mov_b64 exec, -1
    s_nop 1
    s_branch A_back5
A_rare6:
    v_mov_b32 v125, v123
    s_nop 1
    v_permlane32_swap_b32 v125, v123
    s_nop 1
    v_max_f32 v123, v123, v125
    v_max_f32 v123, 0, v123
    v_sub_f32 v60, v60, v123
    v_sub_f32 v61, v61, v123
    v_sub_f32 v62, v62, v123
    v_sub_f32 v63, v63, v123
    v_sub_f32 v64, v64, v123
    v_sub_f32 v65, v65, v123
    v_sub_f32 v66, v66, v123
    v_sub_f32 v67, v67, v123
    v_sub_f32 v68, v68, v123
    v_sub_f32 v69, v69, v123
    v_sub_f32 v70, v70, v123
    v_sub_f32 v71, v71, v123
    v_sub_f32 v72, v72, v123
    v_sub_f32 v73, v73, v123
    v_sub_f32 v74, v74, v123
    v_sub_f32 v75, v75, v123
    s_nop 7
    v_sub_f32 v76, v76, v123
    v_sub_f32 v77, v77, v123
    v_sub_f32 v78, v78, v123
    v_sub_f32 v79, v79, v123
    v_sub_f32 v80, v80, v123
    v_sub_f32 v81, v81, v123
    v_sub_f32 v82, v82, v123
    v_sub_f32 v83, v83, v123
    v_sub_f32 v84, v84, v123
    v_sub_f32 v85, v85, v123
    v_sub_f32 v86, v86, v123
    v_sub_f32 v87, v87, v123
    v_sub_f32 v88, v88, v123
    v_sub_f32 v89, v89, v123
    v_sub_f32 v90, v90, v123
    v_sub_f32 v91, v91, v123
    v_exp_f32 v125, -v123
    s_nop 0
    v_mul_f32 v92, v92, v125
    v_mul_f32 v93, v93, v125
    v_mul_f32 v94, v94, v125
    v_mul_f32 v95, v95, v125
    v_mul_f32 v96, v96, v125
    v_mul_f32 v97, v97, v125
    v_mul_f32 v98, v98, v125
    v_mul_f32 v99, v99, v125
    v_mul_f32 v100, v100, v125
    v_mul_f32 v101, v101, v125
    v_mul_f32 v102, v102, v125
    v_mul_f32 v103, v103, v125
    v_mul_f32 v104, v104, v125
    v_mul_f32 v105, v105, v125
    v_mul_f32 v106, v106, v125
    v_mul_f32 v107, v107, v125
    v_sub_f32 v124, v124, v123
    v_cvt_pk_bf16_f32 v125, v124, v124
    v_lshlrev_b32 v125, 16, v125
    v_sub_f32 v126, v124, v125
    v_cvt_pk_bf16_f32 v125, v126, v126
    v_lshlrev_b32 v125, 16, v125
    v_sub_f32 v125, v126, v125
    s_mov_b64 exec, s[52:53]
    v_cvt_pk_bf16_f32 v10, v124, v126
    v_cvt_pk_bf16_f32 v11, v125, 0
    s_mov_b64 exec, -1
    s_nop 1
    s_branch A_back6
A_rare7:
    v_mov_b32 v125, v123
    s_nop 1
    v_permlane32_swap_b32 v125, v123
    s_nop 1
    v_max_f32 v123, v123, v125
    v_max_f32 v123, 0, v123
    v_sub_f32 v76, v76, v123
    v_sub_f32 v77, v77, v123
    v_sub_f32 v78, v78, v123
    v_sub_f32 v79, v79, v123
    v_sub_f32 v80, v80, v123
    v_sub_f32 v81, v81, v123
    v_sub_f32 v82, v82, v123
    v_sub_f32 v83, v83, v123
    v_sub_f32 v84, v84, v123
    v_sub_f32 v85, v85, v123
    v_sub_f32 v86, v86, v123
    v_sub_f32 v87, v87, v123
    v_sub_f32 v88, v88, v123
    v_sub_f32 v89, v89, v123
    v_sub_f32 v90, v90, v123
    v_sub_f32 v91, v91, v123
    s_nop 7
    v_sub_f32 v60, v60, v123
    v_sub_f32 v61, v61, v123
    v_sub_f32 v62, v62, v123
    v_sub_f32 v63, v63, v123
    v_sub_f32 v64, v64, v123
    v_sub_f32 v65, v65, v123
    v_sub_f32 v66, v66, v123
    v_sub_f32 v67, v67, v123
    v_sub_f32 v68, v68, v123
    v_sub_f32 v69, v69, v123
    v_sub_f32 v70, v70, v123
    v_sub_f32 v71, v71, v123
    v_sub_f32 v72, v72, v123
    v_sub_f32 v73, v73, v123
    v_sub_f32 v74, v74, v123
    v_sub_f32 v75, v75, v123
    v_exp_f32 v125, -v123
    s_nop 0
    v_mul_f32 v92, v92, v125
    v_mul_f32 v93, v93, v125
    v_mul_f32 v94, v94, v125
    v_mul_f32 v95, v95, v125
    v_mul_f32 v96, v96, v125
    v_mul_f32 v97, v97, v125
    v_mul_f32 v98, v98, v125
    v_mul_f32 v99, v99, v125
    v_mul_f32 v100, v100, v125
    v_mul_f32 v101, v101, v125
    v_mul_f32 v102, v102, v125
    v_mul_f32 v103, v103, v125
    v_mul_f32 v104, v104, v125
    v_mul_f32 v105, v105, v125
    v_mul_f32 v106, v106, v125
    v_mul_f32 v107, v107, v125
    v_sub_f32 v124, v124, v123
    v_cvt_pk_bf16_f32 v125, v124, v124
    v_lshlrev_b32 v125, 16, v125
    v_sub_f32 v126, v124, v125
    v_cvt_pk_bf16_f32 v125, v126, v126
    v_lshlrev_b32 v125, 16, v125
    v_sub_f32 v125, v126, v125
    s_mov_b64 exec, s[52:53]
    v_cvt_pk_bf16_f32 v10, v124, v126
    v_cvt_pk_bf16_f32 v11, v125, 0
    s_mov_b64 exec, -1
    s_nop 1
    s_branch A_back7
M_gemm:
    s_sub_u32 s2, s2, 256
    s_load_dwordx4 s[4:7], s[0:1], 48
    s_load_dwordx2 s[14:15], s[0:1], 104
    s_setprio 0
    v_lshrrev_b32 v1, 6, v0
    v_and_b32 v0, 63, v0
    s_nop 0
    v_readfirstlane_b32 s3, v1
    s_waitcnt lgkmcnt(0)
    s_mov_b32 s16, s4
    s_and_b32 s17, s5, 0xffff
    s_mov_b32 s18, 6291456
    s_mov_b32 s19, 0x00020000
    s_mov_b32 s20, s6
    s_and_b32 s21, s7, 0xffff
    s_mov_b32 s22, 3072
    s_mov_b32 s23, 0x00020000
    s_mov_b32 s24, s14
    s_and_b32 s25, s15, 0xffff
    s_mov_b32 s26, 10027008
    s_mov_b32 s27, 0x00020000
    s_mul_hi_u32 s42, s2, 0xAAAAAAB
    s_mul_i32 s43, s42, 24
    s_sub_u32 s43, s2, s43
    s_lshr_b32 s40, s3, 1
    s_and_b32 s40, s40, 1
    s_and_b32 s41, s3, 1
    s_lshl_b32 s44, s43, 7
    s_lshl_b32 s45, s42, 7
    s_add_u32 s45, s45, 2818048
    s_lshr_b32 s73, s3, 1
    s_and_b32 s73, s73, 1
    s_lshl_b32 s70, s3, 11
    s_cmp_ge_u32 s3, 4
    s_cbranch_scc1 dsA_34
    s_mov_b32 s56, s16
    s_mov_b32 s57, s17
    s_mov_b32 s58, s18
    s_mov_b32 s59, s19
    s_mul_i32 s46, s73, 98304
    s_add_u32 s60, s44, s46
    s_mov_b32 s61, 196608
    s_mov_b32 s62, 0
    s_mov_b32 s63, 24576
    s_mov_b32 s64, 49152
    s_mov_b32 s65, 73728
    v_lshrrev_b32 v20, 3, v0
    v_mul_u32_u24 v20, 3072, v20
    v_bfe_u32 v1, v0, 4, 1
    v_lshlrev_b32 v1, 2, v1
    v_and_b32 v21, 7, v0
    v_xor_b32 v1, v1, v21
    v_lshl_add_u32 v20, v1, 4, v20
    v_mov_b32 v21, v20
    s_branch dsB_35
dsA_34:
    s_mov_b32 s56, s24
    s_mov_b32 s57, s25
    s_mov_b32 s58, s26
    s_mov_b32 s59, s27
    s_mul_i32 s46, s73, 40960
    s_add_u32 s60, s45, s46
    s_mov_b32 s61, 81920
    s_mov_b32 s62, 0
    s_mov_b32 s63, 10240
    s_mov_b32 s64, 20480
    s_mov_b32 s65, 30720
    v_lshrrev_b32 v20, 3, v0
    v_mul_u32_u24 v20, 1280, v20
    v_bfe_u32 v1, v0, 4, 1
    v_lshlrev_b32 v1, 2, v1
    v_and_b32 v21, 7, v0
    v_xor_b32 v1, v1, v21
    v_lshl_add_u32 v20, v1, 4, v20
    v_mov_b32 v21, v20
dsB_35:
    s_bitcmp0_b32 s3, 0
    s_cbranch_scc1 ds8_36
    s_mov_b32 s62, s64
    s_mov_b32 s63, s65
ds8_36:
    s_lshl_b32 s46, s40, 12
    v_bfe_u32 v24, v0, 5, 1
    v_lshlrev_b32 v24, 3, v24
    v_bfe_u32 v25, v0, 2, 2
    v_add_u32 v24, v24, v25
    v_bfe_u32 v25, v0, 4, 1
    v_lshlrev_b32 v25, 1, v25
    v_bfe_u32 v26, v0, 1, 1
    v_add_u32 v25, v25, v26
    s_lshl_b32 s47, s40, 2
    v_add_u32 v25, s47, v25
    v_bfe_u32 v26, v24, 1, 1
    v_lshlrev_b32 v26, 2, v26
    v_xor_b32 v25, v25, v26
    v_lshlrev_b32 v24, 7, v24
    v_lshl_add_u32 v24, v25, 4, v24
    v_and_b32 v26, 1, v0
    v_lshl_add_u32 v24, v26, 3, v24
    s_lshl_b32 s46, s41, 12
    s_add_u32 s46, s46, 8192
    v_bfe_u32 v25, v0, 5, 1
    v_lshlrev_b32 v25, 3, v25
    v_bfe_u32 v26, v0, 2, 2
    v_add_u32 v25, v25, v26
    v_bfe_u32 v26, v0, 4, 1
    v_lshlrev_b32 v26, 1, v26
    v_bfe_u32 v27, v0, 1, 1
    v_add_u32 v26, v26, v27
    s_lshl_b32 s47, s41, 2
    v_add_u32 v26, s47, v26
    v_bfe_u32 v27, v25, 1, 1
    v_lshlrev_b32 v27, 2, v27
    v_xor_b32 v26, v26, v27
    v_lshlrev_b32 v25, 7, v25
    v_lshl_add_u32 v25, v26, 4, v25
    v_and_b32 v27, 1, v0
    v_lshl_add_u32 v25, v27, 3, v25
    v_add_u32 v25, 8192, v25
    v_mov_b32 v32, 0
    v_mov_b32 v33, 0
    v_mov_b32 v34, 0
    v_mov_b32 v35, 0
    v_mov_b32 v36, 0
    v_mov_b32 v37, 0
    v_mov_b32 v38, 0
    v_mov_b32 v39, 0
    v_mov_b32 v40, 0
    v_mov_b32 v41, 0
    v_mov_b32 v42, 0
    v_mov_b32 v43, 0
    v_mov_b32 v44, 0
    v_mov_b32 v45, 0
    v_mov_b32 v46, 0
    v_mov_b32 v47, 0
    s_mov_b32 s74, 0
    s_mov_b32 s75, 81920
    s_mov_b32 s90, 0
    s_mov_b32 s91, 0
    s_mov_b32 s92, 28
    s_add_u32 s71, s70, s74
    s_mov_b32 m0, s71
    s_add_u32 s72, s60, s62
    buffer_load_dwordx4 v20, s[56:59], s72 offen lds
    s_add_u32 s71, s70, s74
    s_add_u32 s71, s71, 1024
    s_mov_b32 m0, s71
    s_add_u32 s72, s60, s63
    buffer_load_dwordx4 v21, s[56:59], s72 offen lds
    s_add_u32 s60, s60, s61
    s_add_u32 s74, s74, 16384
    s_cmp_eq_u32 s74, s75
    s_cselect_b32 s74, 0, s74
    s_add_u32 s71, s70, s74
    s_mov_b32 m0, s71
    s_add_u32 s72, s60, s62
    buffer_load_dwordx4 v20, s[56:59], s72 offen lds
    s_add_u32 s71, s70, s74
    s_add_u32 s71, s71, 1024
    s_mov_b32 m0, s71
    s_add_u32 s72, s60, s63
    buffer_load_dwordx4 v21, s[56:59], s72 offen lds
    s_add_u32 s60, s60, s61
    s_add_u32 s74, s74, 16384
    s_cmp_eq_u32 s74, s75
    s_cselect_b32 s74, 0, s74
    s_add_u32 s71, s70, s74
    s_mov_b32 m0, s71
    s_add_u32 s72, s60, s62
    buffer_load_dwordx4 v20, s[56:59], s72 offen lds
    s_add_u32 s71, s70, s74
    s_add_u32 s71, s71, 1024
    s_mov_b32 m0, s71
    s_add_u32 s72, s60, s63
    buffer_load_dwordx4 v21, s[56:59], s72 offen lds
    s_add_u32 s60, s60, s61
    s_add_u32 s74, s74, 16384
    s_cmp_eq_u32 s74, s75
    s_cselect_b32 s74, 0, s74
    s_add_u32 s71, s70, s74
    s_mov_b32 m0, s71
    s_add_u32 s72, s60, s62
    buffer_load_dwordx4 v20, s[56:59], s72 offen lds
    s_add_u32 s71, s70, s74
    s_add_u32 s71, s71, 1024
    s_mov_b32 m0, s71
    s_add_u32 s72, s60, s63
    buffer_load_dwordx4 v21, s[56:59], s72 offen lds
    s_add_u32 s60, s60, s61
    s_add_u32 s74, s74, 16384
    s_cmp_eq_u32 s74, s75
    s_cselect_b32 s74, 0, s74
    s_cmp_ge_u32 s3, 4
    s_cbranch_scc1 g1hi_37
    s_waitcnt lgkmcnt(0)
    s_cmp_lt_u32 s91, s92
    s_cbranch_scc0 gn_39
    s_waitcnt vmcnt(6)
    s_barrier
    v_add_u32 v28, s90, v24
    v_add_u32 v29, s90, v25
    ds_read_b64_tr_b16 v[48:49], v28 offset:0
    ds_read_b64_tr_b16 v[50:51], v28 offset:512
    ds_read_b64_tr_b16 v[52:53], v29 offset:0
    ds_read_b64_tr_b16 v[54:55], v29 offset:512
    ds_read_b64_tr_b16 v[56:57], v28 offset:2048
    ds_read_b64_tr_b16 v[58:59], v28 offset:2560
    ds_read_b64_tr_b16 v[60:61], v29 offset:2048
    ds_read_b64_tr_b16 v[62:63], v29 offset:2560
    s_add_u32 s90, s90, 16384
    s_cmp_eq_u32 s90, s75
    s_cselect_b32 s90, 0, s90
    s_add_u32 s71, s70, s74
    s_mov_b32 m0, s71
    s_add_u32 s72, s60, s62
    buffer_load_dwordx4 v20, s[56:59], s72 offen lds
    s_add_u32 s71, s70, s74
    s_add_u32 s71, s71, 1024
    s_mov_b32 m0, s71
    s_add_u32 s72, s60, s63
    buffer_load_dwordx4 v21, s[56:59], s72 offen lds
    s_add_u32 s60, s60, s61
    s_add_u32 s74, s74, 16384
    s_cmp_eq_u32 s74, s75
    s_cselect_b32 s74, 0, s74
    s_branch gg_40
gn_39:
    s_waitcnt vmcnt(0)
    s_barrier
    v_add_u32 v28, s90, v24
    v_add_u32 v29, s90, v25
    ds_read_b64_tr_b16 v[48:49], v28 offset:0
    ds_read_b64_tr_b16 v[50:51], v28 offset:512
    ds_read_b64_tr_b16 v[52:53], v29 offset:0
    ds_read_b64_tr_b16 v[54:55], v29 offset:512
    ds_read_b64_tr_b16 v[56:57], v28 offset:2048
    ds_read_b64_tr_b16 v[58:59], v28 offset:2560
    ds_read_b64_tr_b16 v[60:61], v29 offset:2048
    ds_read_b64_tr_b16 v[62:63], v29 offset:2560
    s_add_u32 s90, s90, 16384
    s_cmp_eq_u32 s90, s75
    s_cselect_b32 s90, 0, s90
gg_40:
    s_add_u32 s91, s91, 1
gl_41:
    s_waitcnt lgkmcnt(0)
    s_cmp_lt_u32 s91, s92
    s_cbranch_scc0 gn_42
    s_waitcnt vmcnt(6)
    s_barrier
    v_add_u32 v28, s90, v24
    v_add_u32 v29, s90, v25
    v_mfma_f32_32x32x16_bf16 v[32:47], v[48:51], v[52:55], v[32:47]
    ds_read_b64_tr_b16 v[64:65], v28 offset:0
    ds_read_b64_tr_b16 v[66:67], v28 offset:512
    ds_read_b64_tr_b16 v[68:69], v29 offset:0
    ds_read_b64_tr_b16 v[70:71], v29 offset:512
    v_mfma_f32_32x32x16_bf16 v[32:47], v[56:59], v[60:63], v[32:47]
    ds_read_b64_tr_b16 v[72:73], v28 offset:2048
    ds_read_b64_tr_b16 v[74:75], v28 offset:2560
    ds_read_b64_tr_b16 v[76:77], v29 offset:2048
    ds_read_b64_tr_b16 v[78:79], v29 offset:2560
    s_add_u32 s90, s90, 16384
    s_cmp_eq_u32 s90, s75
    s_cselect_b32 s90, 0, s90
    s_add_u32 s71, s70, s74
    s_mov_b32 m0, s71
    s_add_u32 s72, s60, s62
    buffer_load_dwordx4 v20, s[56:59], s72 offen lds
    s_add_u32 s71, s70, s74
    s_add_u32 s71, s71, 1024
    s_mov_b32 m0, s71
    s_add_u32 s72, s60, s63
    buffer_load_dwordx4 v21, s[56:59], s72 offen lds
    s_add_u32 s60, s60, s61
    s_add_u32 s74, s74, 16384
    s_cmp_eq_u32 s74, s75
    s_cselect_b32 s74, 0, s74
    s_branch gg_43
gn_42:
    s_waitcnt vmcnt(0)
    s_barrier
    v_add_u32 v28, s90, v24
    v_add_u32 v29, s90, v25
    v_mfma_f32_32x32x16_bf16 v[32:47], v[48:51], v[52:55], v[32:47]
    ds_read_b64_tr_b16 v[64:65], v28 offset:0
    ds_read_b64_tr_b16 v[66:67], v28 offset:512
    ds_read_b64_tr_b16 v[68:69], v29 offset:0
    ds_read_b64_tr_b16 v[70:71], v29 offset:512
    v_mfma_f32_32x32x16_bf16 v[32:47], v[56:59], v[60:63], v[32:47]
    ds_read_b64_tr_b16 v[72:73], v28 offset:2048
    ds_read_b64_tr_b16 v[74:75], v28 offset:2560
    ds_read_b64_tr_b16 v[76:77], v29 offset:2048
    ds_read_b64_tr_b16 v[78:79], v29 offset:2560
    s_add_u32 s90, s90, 16384
    s_cmp_eq_u32 s90, s75
    s_cselect_b32 s90, 0, s90
gg_43:
    s_add_u32 s91, s91, 1
    s_waitcnt lgkmcnt(0)
    s_cmp_lt_u32 s91, s92
    s_cbranch_scc0 gn_44
    s_waitcnt vmcnt(6)
    s_barrier
    v_add_u32 v28, s90, v24
    v_add_u32 v29, s90, v25
    v_mfma_f32_32x32x16_bf16 v[32:47], v[64:67], v[68:71], v[32:47]
    ds_read_b64_tr_b16 v[48:49], v28 offset:0
    ds_read_b64_tr_b16 v[50:51], v28 offset:512
    ds_read_b64_tr_b16 v[52:53], v29 offset:0
    ds_read_b64_tr_b16 v[54:55], v29 offset:512
    v_mfma_f32_32x32x16_bf16 v[32:47], v[72:75], v[76:79], v[32:47]
    ds_read_b64_tr_b16 v[56:57], v28 offset:2048
    ds_read_b64_tr_b16 v[58:59], v28 offset:2560
    ds_read_b64_tr_b16 v[60:61], v29 offset:2048
    ds_read_b64_tr_b16 v[62:63], v29 offset:2560
    s_add_u32 s90, s90, 16384
    s_cmp_eq_u32 s90, s75
    s_cselect_b32 s90, 0, s90
    s_add_u32 s71, s70, s74
    s_mov_b32 m0, s71
    s_add_u32 s72, s60, s62
    buffer_load_dwordx4 v20, s[56:59], s72 offen lds
    s_add_u32 s71, s70, s74
    s_add_u32 s71, s71, 1024
    s_mov_b32 m0, s71
    s_add_u32 s72, s60, s63
    buffer_load_dwordx4 v21, s[56:59], s72 offen lds
    s_add_u32 s60, s60, s61
    s_add_u32 s74, s74, 16384
    s_cmp_eq_u32 s74, s75
    s_cselect_b32 s74, 0, s74
    s_branch gg_45
gn_44:
    s_waitcnt vmcnt(0)
    s_barrier
    v_add_u32 v28, s90, v24
    v_add_u32 v29, s90, v25
    v_mfma_f32_32x32x16_bf16 v[32:47], v[64:67], v[68:71], v[32:47]
    ds_read_b64_tr_b16 v[48:49], v28 offset:0
    ds_read_b64_tr_b16 v[50:51], v28 offset:512
    ds_read_b64_tr_b16 v[52:53], v29 offset:0
    ds_read_b64_tr_b16 v[54:55], v29 offset:512
    v_mfma_f32_32x32x16_bf16 v[32:47], v[72:75], v[76:79], v[32:47]
    ds_read_b64_tr_b16 v[56:57], v28 offset:2048
    ds_read_b64_tr_b16 v[58:59], v28 offset:2560
    ds_read_b64_tr_b16 v[60:61], v29 offset:2048
    ds_read_b64_tr_b16 v[62:63], v29 offset:2560
    s_add_u32 s90, s90, 16384
    s_cmp_eq_u32 s90, s75
    s_cselect_b32 s90, 0, s90
gg_45:
    s_add_u32 s91, s91, 1
    s_cmp_lt_u32 s91, 31
    s_cbranch_scc1 gl_41
    s_waitcnt lgkmcnt(0)
    s_cmp_lt_u32 s91, s92
    s_cbranch_scc0 gn_46
    s_waitcnt vmcnt(6)
    s_barrier
    v_add_u32 v28, s90, v24
    v_add_u32 v29, s90, v25
    v_mfma_f32_32x32x16_bf16 v[32:47], v[48:51], v[52:55], v[32:47]
    ds_read_b64_tr_b16 v[64:65], v28 offset:0
    ds_read_b64_tr_b16 v[66:67], v28 offset:512
    ds_read_b64_tr_b16 v[68:69], v29 offset:0
    ds_read_b64_tr_b16 v[70:71], v29 offset:512
    v_mfma_f32_32x32x16_bf16 v[32:47], v[56:59], v[60:63], v[32:47]
    ds_read_b64_tr_b16 v[72:73], v28 offset:2048
    ds_read_b64_tr_b16 v[74:75], v28 offset:2560
    ds_read_b64_tr_b16 v[76:77], v29 offset:2048
    ds_read_b64_tr_b16 v[78:79], v29 offset:2560
    s_add_u32 s90, s90, 16384
    s_cmp_eq_u32 s90, s75
    s_cselect_b32 s90, 0, s90
    s_add_u32 s71, s70, s74
    s_mov_b32 m0, s71
    s_add_u32 s72, s60, s62
    buffer_load_dwordx4 v20, s[56:59], s72 offen lds
    s_add_u32 s71, s70, s74
    s_add_u32 s71, s71, 1024
    s_mov_b32 m0, s71
    s_add_u32 s72, s60, s63
    buffer_load_dwordx4 v21, s[56:59], s72 offen lds
    s_add_u32 s60, s60, s61
    s_add_u32 s74, s74, 16384
    s_cmp_eq_u32 s74, s75
    s_cselect_b32 s74, 0, s74
    s_branch gg_47
gn_46:
    s_waitcnt vmcnt(0)
    s_barrier
    v_add_u32 v28, s90, v24
    v_add_u32 v29, s90, v25
    v_mfma_f32_32x32x16_bf16 v[32:47], v[48:51], v[52:55], v[32:47]
    ds_read_b64_tr_b16 v[64:65], v28 offset:0
    ds_read_b64_tr_b16 v[66:67], v28 offset:512
    ds_read_b64_tr_b16 v[68:69], v29 offset:0
    ds_read_b64_tr_b16 v[70:71], v29 offset:512
    v_mfma_f32_32x32x16_bf16 v[32:47], v[56:59], v[60:63], v[32:47]
    ds_read_b64_tr_b16 v[72:73], v28 offset:2048
    ds_read_b64_tr_b16 v[74:75], v28 offset:2560
    ds_read_b64_tr_b16 v[76:77], v29 offset:2048
    ds_read_b64_tr_b16 v[78:79], v29 offset:2560
    s_add_u32 s90, s90, 16384
    s_cmp_eq_u32 s90, s75
    s_cselect_b32 s90, 0, s90
gg_47:
    s_add_u32 s91, s91, 1
    s_waitcnt lgkmcnt(0)
    v_mfma_f32_32x32x16_bf16 v[32:47], v[64:67], v[68:71], v[32:47]
    v_mfma_f32_32x32x16_bf16 v[32:47], v[72:75], v[76:79], v[32:47]
    s_barrier
    s_barrier
    v_lshlrev_b32 v4, 2, v0
    s_and_b32 s46, s3, 3
    s_lshl_b32 s46, s46, 12
    v_add_u32 v4, s46, v4
    ds_read_b32 v48, v4 offset:0
    ds_read_b32 v49, v4 offset:256
    ds_read_b32 v50, v4 offset:512
    ds_read_b32 v51, v4 offset:768
    ds_read_b32 v52, v4 offset:1024
    ds_read_b32 v53, v4 offset:1280
    ds_read_b32 v54, v4 offset:1536
    ds_read_b32 v55, v4 offset:1792
    ds_read_b32 v56, v4 offset:2048
    ds_read_b32 v57, v4 offset:2304
    ds_read_b32 v58, v4 offset:2560
    ds_read_b32 v59, v4 offset:2816
    ds_read_b32 v60, v4 offset:3072
    ds_read_b32 v61, v4 offset:3328
    ds_read_b32 v62, v4 offset:3584
    ds_read_b32 v63, v4 offset:3840
    s_waitcnt lgkmcnt(0)
    v_add_f32 v32, v32, v48
    v_add_f32 v33, v33, v49
    v_add_f32 v34, v34, v50
    v_add_f32 v35, v35, v51
    v_add_f32 v36, v36, v52
    v_add_f32 v37, v37, v53
    v_add_f32 v38, v38, v54
    v_add_f32 v39, v39, v55
    v_add_f32 v40, v40, v56
    v_add_f32 v41, v41, v57
    v_add_f32 v42, v42, v58
    v_add_f32 v43, v43, v59
    v_add_f32 v44, v44, v60
    v_add_f32 v45, v45, v61
    v_add_f32 v46, v46, v62
    v_add_f32 v47, v47, v63
    s_branch g1j_38
g1hi_37:
    s_waitcnt lgkmcnt(0)
    s_cmp_lt_u32 s91, s92
    s_cbranch_scc0 gn_48
    s_waitcnt vmcnt(6)
    s_barrier
    v_add_u32 v28, s90, v24
    v_add_u32 v29, s90, v25
    ds_read_b64_tr_b16 v[48:49], v28 offset:4096
    ds_read_b64_tr_b16 v[50:51], v28 offset:4608
    ds_read_b64_tr_b16 v[52:53], v29 offset:4096
    ds_read_b64_tr_b16 v[54:55], v29 offset:4608
    ds_read_b64_tr_b16 v[56:57], v28 offset:6144
    ds_read_b64_tr_b16 v[58:59], v28 offset:6656
    ds_read_b64_tr_b16 v[60:61], v29 offset:6144
    ds_read_b64_tr_b16 v[62:63], v29 offset:6656
    s_add_u32 s90, s90, 16384
    s_cmp_eq_u32 s90, s75
    s_cselect_b32 s90, 0, s90
    s_add_u32 s71, s70, s74
    s_mov_b32 m0, s71
    s_add_u32 s72, s60, s62
    buffer_load_dwordx4 v20, s[56:59], s72 offen lds
    s_add_u32 s71, s70, s74
    s_add_u32 s71, s71, 1024
    s_mov_b32 m0, s71
    s_add_u32 s72, s60, s63
    buffer_load_dwordx4 v21, s[56:59], s72 offen lds
    s_add_u32 s60, s60, s61
    s_add_u32 s74, s74, 16384
    s_cmp_eq_u32 s74, s75
    s_cselect_b32 s74, 0, s74
    s_branch gg_49
gn_48:
    s_waitcnt vmcnt(0)
    s_barrier
    v_add_u32 v28, s90, v24
    v_add_u32 v29, s90, v25
    ds_read_b64_tr_b16 v[48:49], v28 offset:4096
    ds_read_b64_tr_b16 v[50:51], v28 offset:4608
    ds_read_b64_tr_b16 v[52:53], v29 offset:4096
    ds_read_b64_tr_b16 v[54:55], v29 offset:4608
    ds_read_b64_tr_b16 v[56:57], v28 offset:6144
    ds_read_b64_tr_b16 v[58:59], v28 offset:6656
    ds_read_b64_tr_b16 v[60:61], v29 offset:6144
    ds_read_b64_tr_b16 v[62:63], v29 offset:6656
    s_add_u32 s90, s90, 16384
    s_cmp_eq_u32 s90, s75
    s_cselect_b32 s90, 0, s90
gg_49:
    s_add_u32 s91, s91, 1
gl_50:
    s_waitcnt lgkmcnt(0)
    s_cmp_lt_u32 s91, s92
    s_cbranch_scc0 gn_51
    s_waitcnt vmcnt(6)
    s_barrier
    v_add_u32 v28, s90, v24
    v_add_u32 v29, s90, v25
    v_mfma_f32_32x32x16_bf16 v[32:47], v[48:51], v[52:55], v[32:47]
    ds_read_b64_tr_b16 v[64:65], v28 offset:4096
    ds_read_b64_tr_b16 v[66:67], v28 offset:4608
    ds_read_b64_tr_b16 v[68:69], v29 offset:4096
    ds_read_b64_tr_b16 v[70:71], v29 offset:4608
    v_mfma_f32_32x32x16_bf16 v[32:47], v[56:59], v[60:63], v[32:47]
    ds_read_b64_tr_b16 v[72:73], v28 offset:6144
    ds_read_b64_tr_b16 v[74:75], v28 offset:6656
    ds_read_b64_tr_b16 v[76:77], v29 offset:6144
    ds_read_b64_tr_b16 v[78:79], v29 offset:6656
    s_add_u32 s90, s90, 16384
    s_cmp_eq_u32 s90, s75
    s_cselect_b32 s90, 0, s90
    s_add_u32 s71, s70, s74
    s_mov_b32 m0, s71
    s_add_u32 s72, s60, s62
    buffer_load_dwordx4 v20, s[56:59], s72 offen lds
    s_add_u32 s71, s70, s74
    s_add_u32 s71, s71, 1024
    s_mov_b32 m0, s71
    s_add_u32 s72, s60, s63
    buffer_load_dwordx4 v21, s[56:59], s72 offen lds
    s_add_u32 s60, s60, s61
    s_add_u32 s74, s74, 16384
    s_cmp_eq_u32 s74, s75
    s_cselect_b32 s74, 0, s74
    s_branch gg_52
gn_51:
    s_waitcnt vmcnt(0)
    s_barrier
    v_add_u32 v28, s90, v24
    v_add_u32 v29, s90, v25
    v_mfma_f32_32x32x16_bf16 v[32:47], v[48:51], v[52:55], v[32:47]
    ds_read_b64_tr_b16 v[64:65], v28 offset:4096
    ds_read_b64_tr_b16 v[66:67], v28 offset:4608
    ds_read_b64_tr_b16 v[68:69], v29 offset:4096
    ds_read_b64_tr_b16 v[70:71], v29 offset:4608
    v_mfma_f32_32x32x16_bf16 v[32:47], v[56:59], v[60:63], v[32:47]
    ds_read_b64_tr_b16 v[72:73], v28 offset:6144
    ds_read_b64_tr_b16 v[74:75], v28 offset:6656
    ds_read_b64_tr_b16 v[76:77], v29 offset:6144
    ds_read_b64_tr_b16 v[78:79], v29 offset:6656
    s_add_u32 s90, s90, 16384
    s_cmp_eq_u32 s90, s75
    s_cselect_b32 s90, 0, s90
gg_52:
    s_add_u32 s91, s91, 1
    s_waitcnt lgkmcnt(0)
    s_cmp_lt_u32 s91, s92
    s_cbranch_scc0 gn_53
    s_waitcnt vmcnt(6)
    s_barrier
    v_add_u32 v28, s90, v24
    v_add_u32 v29, s90, v25
    v_mfma_f32_32x32x16_bf16 v[32:47], v[64:67], v[68:71], v[32:47]
    ds_read_b64_tr_b16 v[48:49], v28 offset:4096
    ds_read_b64_tr_b16 v[50:51], v28 offset:4608
    ds_read_b64_tr_b16 v[52:53], v29 offset:4096
    ds_read_b64_tr_b16 v[54:55], v29 offset:4608
    v_mfma_f32_32x32x16_bf16 v[32:47], v[72:75], v[76:79], v[32:47]
    ds_read_b64_tr_b16 v[56:57], v28 offset:6144
    ds_read_b64_tr_b16 v[58:59], v28 offset:6656
    ds_read_b64_tr_b16 v[60:61], v29 offset:6144
    ds_read_b64_tr_b16 v[62:63], v29 offset:6656
    s_add_u32 s90, s90, 16384
    s_cmp_eq_u32 s90, s75
    s_cselect_b32 s90, 0, s90
    s_add_u32 s71, s70, s74
    s_mov_b32 m0, s71
    s_add_u32 s72, s60, s62
    buffer_load_dwordx4 v20, s[56:59], s72 offen lds
    s_add_u32 s71, s70, s74
    s_add_u32 s71, s71, 1024
    s_mov_b32 m0, s71
    s_add_u32 s72, s60, s63
    buffer_load_dwordx4 v21, s[56:59], s72 offen lds
    s_add_u32 s60, s60, s61
    s_add_u32 s74, s74, 16384
    s_cmp_eq_u32 s74, s75
    s_cselect_b32 s74, 0, s74
    s_branch gg_54
gn_53:
    s_waitcnt vmcnt(0)
    s_barrier
    v_add_u32 v28, s90, v24
    v_add_u32 v29, s90, v25
    v_mfma_f32_32x32x16_bf16 v[32:47], v[64:67], v[68:71], v[32:47]
    ds_read_b64_tr_b16 v[48:49], v28 offset:4096
    ds_read_b64_tr_b16 v[50:51], v28 offset:4608
    ds_read_b64_tr_b16 v[52:53], v29 offset:4096
    ds_read_b64_tr_b16 v[54:55], v29 offset:4608
    v_mfma_f32_32x32x16_bf16 v[32:47], v[72:75], v[76:79], v[32:47]
    ds_read_b64_tr_b16 v[56:57], v28 offset:6144
    ds_read_b64_tr_b16 v[58:59], v28 offset:6656
    ds_read_b64_tr_b16 v[60:61], v29 offset:6144
    ds_read_b64_tr_b16 v[62:63], v29 offset:6656
    s_add_u32 s90, s90, 16384
    s_cmp_eq_u32 s90, s75
    s_cselect_b32 s90, 0, s90
gg_54:
    s_add_u32 s91, s91, 1
    s_cmp_lt_u32 s91, 31
    s_cbranch_scc1 gl_50
    s_waitcnt lgkmcnt(0)
    s_cmp_lt_u32 s91, s92
    s_cbranch_scc0 gn_55
    s_waitcnt vmcnt(6)
    s_barrier
    v_add_u32 v28, s90, v24
    v_add_u32 v29, s90, v25
    v_mfma_f32_32x32x16_bf16 v[32:47], v[48:51], v[52:55], v[32:47]
    ds_read_b64_tr_b16 v[64:65], v28 offset:4096
    ds_read_b64_tr_b16 v[66:67], v28 offset:4608
    ds_read_b64_tr_b16 v[68:69], v29 offset:4096
    ds_read_b64_tr_b16 v[70:71], v29 offset:4608
    v_mfma_f32_32x32x16_bf16 v[32:47], v[56:59], v[60:63], v[32:47]
    ds_read_b64_tr_b16 v[72:73], v28 offset:6144
    ds_read_b64_tr_b16 v[74:75], v28 offset:6656
    ds_read_b64_tr_b16 v[76:77], v29 offset:6144
    ds_read_b64_tr_b16 v[78:79], v29 offset:6656
    s_add_u32 s90, s90, 16384
    s_cmp_eq_u32 s90, s75
    s_cselect_b32 s90, 0, s90
    s_add_u32 s71, s70, s74
    s_mov_b32 m0, s71
    s_add_u32 s72, s60, s62
    buffer_load_dwordx4 v20, s[56:59], s72 offen lds
    s_add_u32 s71, s70, s74
    s_add_u32 s71, s71, 1024
    s_mov_b32 m0, s71
    s_add_u32 s72, s60, s63
    buffer_load_dwordx4 v21, s[56:59], s72 offen lds
    s_add_u32 s60, s60, s61
    s_add_u32 s74, s74, 16384
    s_cmp_eq_u32 s74, s75
    s_cselect_b32 s74, 0, s74
    s_branch gg_56
gn_55:
    s_waitcnt vmcnt(0)
    s_barrier
    v_add_u32 v28, s90, v24
    v_add_u32 v29, s90, v25
    v_mfma_f32_32x32x16_bf16 v[32:47], v[48:51], v[52:55], v[32:47]
    ds_read_b64_tr_b16 v[64:65], v28 offset:4096
    ds_read_b64_tr_b16 v[66:67], v28 offset:4608
    ds_read_b64_tr_b16 v[68:69], v29 offset:4096
    ds_read_b64_tr_b16 v[70:71], v29 offset:4608
    v_mfma_f32_32x32x16_bf16 v[32:47], v[56:59], v[60:63], v[32:47]
    ds_read_b64_tr_b16 v[72:73], v28 offset:6144
    ds_read_b64_tr_b16 v[74:75], v28 offset:6656
    ds_read_b64_tr_b16 v[76:77], v29 offset:6144
    ds_read_b64_tr_b16 v[78:79], v29 offset:6656
    s_add_u32 s90, s90, 16384
    s_cmp_eq_u32 s90, s75
    s_cselect_b32 s90, 0, s90
gg_56:
    s_add_u32 s91, s91, 1
    s_waitcnt lgkmcnt(0)
    v_mfma_f32_32x32x16_bf16 v[32:47], v[64:67], v[68:71], v[32:47]
    v_mfma_f32_32x32x16_bf16 v[32:47], v[72:75], v[76:79], v[32:47]
    s_barrier
    v_lshlrev_b32 v4, 2, v0
    s_and_b32 s46, s3, 3
    s_lshl_b32 s46, s46, 12
    v_add_u32 v4, s46, v4
    s_nop 7
    ds_write_b32 v4, v32 offset:0
    ds_write_b32 v4, v33 offset:256
    ds_write_b32 v4, v34 offset:512
    ds_write_b32 v4, v35 offset:768
    ds_write_b32 v4, v36 offset:1024
    ds_write_b32 v4, v37 offset:1280
    ds_write_b32 v4, v38 offset:1536
    ds_write_b32 v4, v39 offset:1792
    ds_write_b32 v4, v40 offset:2048
    ds_write_b32 v4, v41 offset:2304
    ds_write_b32 v4, v42 offset:2560
    ds_write_b32 v4, v43 offset:2816
    ds_write_b32 v4, v44 offset:3072
    ds_write_b32 v4, v45 offset:3328
    ds_write_b32 v4, v46 offset:3584
    ds_write_b32 v4, v47 offset:3840
    s_waitcnt lgkmcnt(0)
    s_barrier
    s_endpgm
g1j_38:
    v_and_b32 v2, 31, v0
    v_lshrrev_b32 v3, 5, v0
    s_lshl_b32 s50, s43, 7
    s_lshl_b32 s51, s40, 6
    s_add_u32 s50, s50, s51
    v_lshlrev_b32 v4, 3, v3
    buffer_load_dwordx2 v[80:81], v4, s[20:23], s50 offen offset:0
    buffer_load_dwordx2 v[82:83], v4, s[20:23], s50 offen offset:16
    buffer_load_dwordx2 v[84:85], v4, s[20:23], s50 offen offset:32
    buffer_load_dwordx2 v[86:87], v4, s[20:23], s50 offen offset:48
    s_lshl_b32 s51, s42, 6
    s_lshl_b32 s52, s41, 5
    s_add_u32 s51, s51, s52
    v_add_u32 v6, s51, v2
    v_mul_u32_u24 v6, 3072, v6
    v_add_u32 v6, v6, v4
    s_add_u32 s50, s50, 8060928
    s_mov_b32 s52, 1027024659
    s_mov_b32 s53, 3222493025
    s_waitcnt vmcnt(0)
    s_nop 7
    v_lshlrev_b32 v90, 16, v80
    v_add_f32 v32, v32, v90
    v_mul_f32 v91, v32, v32
    v_fma_f32 v91, v91, s52, 1.0
    v_mul_f32 v91, v91, v32
    v_mul_f32 v91, s53, v91
    v_exp_f32 v91, v91
    s_nop 0
    v_add_f32 v91, 1.0, v91
    v_rcp_f32 v91, v91
    s_nop 0
    v_mul_f32 v32, v32, v91
    v_and_b32 v90, 0xffff0000, v80
    v_add_f32 v33, v33, v90
    v_mul_f32 v91, v33, v33
    v_fma_f32 v91, v91, s52, 1.0
    v_mul_f32 v91, v91, v33
    v_mul_f32 v91, s53, v91
    v_exp_f32 v91, v91
    s_nop 0
    v_add_f32 v91, 1.0, v91
    v_rcp_f32 v91, v91
    s_nop 0
    v_mul_f32 v33, v33, v91
    v_lshlrev_b32 v90, 16, v81
    v_add_f32 v34, v34, v90
    v_mul_f32 v91, v34, v34
    v_fma_f32 v91, v91, s52, 1.0
    v_mul_f32 v91, v91, v34
    v_mul_f32 v91, s53, v91
    v_exp_f32 v91, v91
    s_nop 0
    v_add_f32 v91, 1.0, v91
    v_rcp_f32 v91, v91
    s_nop 0
    v_mul_f32 v34, v34, v91
    v_and_b32 v90, 0xffff0000, v81
    v_add_f32 v35, v35, v90
    v_mul_f32 v91, v35, v35
    v_fma_f32 v91, v91, s52, 1.0
    v_mul_f32 v91, v91, v35
    v_mul_f32 v91, s53, v91
    v_exp_f32 v91, v91
    s_nop 0
    v_add_f32 v91, 1.0, v91
    v_rcp_f32 v91, v91
    s_nop 0
    v_mul_f32 v35, v35, v91
    v_cvt_pk_bf16_f32 v92, v32, v33
    v_cvt_pk_bf16_f32 v93, v34, v35
    buffer_store_dwordx2 v[92:93], v6, s[24:27], s50 offen offset:0
    s_nop 1
    v_lshlrev_b32 v90, 16, v82
    v_add_f32 v36, v36, v90
    v_mul_f32 v91, v36, v36
    v_fma_f32 v91, v91, s52, 1.0
    v_mul_f32 v91, v91, v36
    v_mul_f32 v91, s53, v91
    v_exp_f32 v91, v91
    s_nop 0
    v_add_f32 v91, 1.0, v91
    v_rcp_f32 v91, v91
    s_nop 0
    v_mul_f32 v36, v36, v91
    v_and_b32 v90, 0xffff0000, v82
    v_add_f32 v37, v37, v90
    v_mul_f32 v91, v37, v37
    v_fma_f32 v91, v91, s52, 1.0
    v_mul_f32 v91, v91, v37
    v_mul_f32 v91, s53, v91
    v_exp_f32 v91, v91
    s_nop 0
    v_add_f32 v91, 1.0, v91
    v_rcp_f32 v91, v91
    s_nop 0
    v_mul_f32 v37, v37, v91
    v_lshlrev_b32 v90, 16, v83
    v_add_f32 v38, v38, v90
    v_mul_f32 v91, v38, v38
    v_fma_f32 v91, v91, s52, 1.0
    v_mul_f32 v91, v91, v38
    v_mul_f32 v91, s53, v91
    v_exp_f32 v91, v91
    s_nop 0
    v_add_f32 v91, 1.0, v91
    v_rcp_f32 v91, v91
    s_nop 0
    v_mul_f32 v38, v38, v91
    v_and_b32 v90, 0xffff0000, v83
    v_add_f32 v39, v39, v90
    v_mul_f32 v91, v39, v39
    v_fma_f32 v91, v91, s52, 1.0
    v_mul_f32 v91, v91, v39
    v_mul_f32 v91, s53, v91
    v_exp_f32 v91, v91
    s_nop 0
    v_add_f32 v91, 1.0, v91
    v_rcp_f32 v91, v91
    s_nop 0
    v_mul_f32 v39, v39, v91
    v_cvt_pk_bf16_f32 v92, v36, v37
    v_cvt_pk_bf16_f32 v93, v38, v39
    buffer_store_dwordx2 v[92:93], v6, s[24:27], s50 offen offset:16
    s_nop 1
    v_lshlrev_b32 v90, 16, v84
    v_add_f32 v40, v40, v90
    v_mul_f32 v91, v40, v40
    v_fma_f32 v91, v91, s52, 1.0
    v_mul_f32 v91, v91, v40
    v_mul_f32 v91, s53, v91
    v_exp_f32 v91, v91
    s_nop 0
    v_add_f32 v91, 1.0, v91
    v_rcp_f32 v91, v91
    s_nop 0
    v_mul_f32 v40, v40, v91
    v_and_b32 v90, 0xffff0000, v84
    v_add_f32 v41, v41, v90
    v_mul_f32 v91, v41, v41
    v_fma_f32 v91, v91, s52, 1.0
    v_mul_f32 v91, v91, v41
    v_mul_f32 v91, s53, v91
    v_exp_f32 v91, v91
    s_nop 0
    v_add_f32 v91, 1.0, v91
    v_rcp_f32 v91, v91
    s_nop 0
    v_mul_f32 v41, v41, v91
    v_lshlrev_b32 v90, 16, v85
    v_add_f32 v42, v42, v90
    v_mul_f32 v91, v42, v42
    v_fma_f32 v91, v91, s52, 1.0
    v_mul_f32 v91, v91, v42
    v_mul_f32 v91, s53, v91
    v_exp_f32 v91, v91
    s_nop 0
    v_add_f32 v91, 1.0, v91
    v_rcp_f32 v91, v91
    s_nop 0
    v_mul_f32 v42, v42, v91
    v_and_b32 v90, 0xffff0000, v85
    v_add_f32 v43, v43, v90
    v_mul_f32 v91, v43, v43
    v_fma_f32 v91, v91, s52, 1.0
    v_mul_f32 v91, v91, v43
    v_mul_f32 v91, s53, v91
    v_exp_f32 v91, v91
    s_nop 0
    v_add_f32 v91, 1.0, v91
    v_rcp_f32 v91, v91
    s_nop 0
    v_mul_f32 v43, v43, v91
    v_cvt_pk_bf16_f32 v92, v40, v41
    v_cvt_pk_bf16_f32 v93, v42, v43
    buffer_store_dwordx2 v[92:93], v6, s[24:27], s50 offen offset:32
    s_nop 1
    v_lshlrev_b32 v90, 16, v86
    v_add_f32 v44, v44, v90
    v_mul_f32 v91, v44, v44
    v_fma_f32 v91, v91, s52, 1.0
    v_mul_f32 v91, v91, v44
    v_mul_f32 v91, s53, v91
    v_exp_f32 v91, v91
    s_nop 0
    v_add_f32 v91, 1.0, v91
    v_rcp_f32 v91, v91
    s_nop 0
    v_mul_f32 v44, v44, v91
    v_and_b32 v90, 0xffff0000, v86
    v_add_f32 v45, v45, v90
    v_mul_f32 v91, v45, v45
    v_fma_f32 v91, v91, s52, 1.0
    v_mul_f32 v91, v91, v45
    v_mul_f32 v91, s53, v91
    v_exp_f32 v91, v91
    s_nop 0
    v_add_f32 v91, 1.0, v91
    v_rcp_f32 v91, v91
    s_nop 0
    v_mul_f32 v45, v45, v91
    v_lshlrev_b32 v90, 16, v87
    v_add_f32 v46, v46, v90
    v_mul_f32 v91, v46, v46
    v_fma_f32 v91, v91, s52, 1.0
    v_mul_f32 v91, v91, v46
    v_mul_f32 v91, s53, v91
    v_exp_f32 v91, v91
    s_nop 0
    v_add_f32 v91, 1.0, v91
    v_rcp_f32 v91, v91
    s_nop 0
    v_mul_f32 v46, v46, v91
    v_and_b32 v90, 0xffff0000, v87
    v_add_f32 v47, v47, v90
    v_mul_f32 v91, v47, v47
    v_fma_f32 v91, v91, s52, 1.0
    v_mul_f32 v91, v91, v47
    v_mul_f32 v91, s53, v91
    v_exp_f32 v91, v91
    s_nop 0
    v_add_f32 v91, 1.0, v91
    v_rcp_f32 v91, v91
    s_nop 0
    v_mul_f32 v47, v47, v91
    v_cvt_pk_bf16_f32 v92, v44, v45
    v_cvt_pk_bf16_f32 v93, v46, v47
    buffer_store_dwordx2 v[92:93], v6, s[24:27], s50 offen offset:48
    s_nop 1
    s_endpgm
M_exit:
    s_endpgm
    .text
    .globl final_kernel
    .p2align 8
    .type final_kernel,@function
final_kernel:
    s_cmp_ge_u32 s2, 256
    s_cbranch_scc1 F_exit
    s_load_dwordx2 s[4:5], s[0:1], 32
    s_load_dwordx4 s[8:11], s[0:1], 64
    s_load_dwordx2 s[12:13], s[0:1], 88
    s_load_dwordx2 s[14:15], s[0:1], 104
    v_lshrrev_b32 v1, 6, v0
    v_and_b32 v0, 63, v0
    s_nop 0
    v_readfirstlane_b32 s3, v1
    s_waitcnt lgkmcnt(0)
    s_mov_b32 s16, s4
    s_and_b32 s17, s5, 0xffff
    s_mov_b32 s18, 819200
    s_mov_b32 s19, 0x00020000
    s_mov_b32 s20, s8
    s_and_b32 s21, s9, 0xffff
    s_mov_b32 s22, 6291456
    s_mov_b32 s23, 0x00020000
    s_mov_b32 s24, s14
    s_and_b32 s25, s15, 0xffff
    s_mov_b32 s26, 10027008
    s_mov_b32 s27, 0x00020000
    s_mov_b32 s28, s10
    s_and_b32 s29, s11, 0xffff
    s_mov_b32 s30, 4096
    s_mov_b32 s31, 0x00020000
    s_mov_b32 s32, s12
    s_and_b32 s33, s13, 0xffff
    s_mov_b32 s34, 2621440
    s_mov_b32 s35, 0x00020000
    s_and_b32 s43, s2, 31
    s_lshr_b32 s42, s2, 5
    s_and_b32 s41, s3, 1
    s_lshr_b32 s40, s3, 1
    v_and_b32 v2, 31, v0
    v_lshrrev_b32 v3, 5, v0
    s_mul_i32 s36, s42, 160
    s_mul_i32 s37, s43, 81920
    s_add_u32 s37, s37, 5439488
    s_mul_i32 s39, s42, 245760
    s_add_u32 s39, s39, 8060928
    s_lshl_b32 s44, s43, 7
    v_lshrrev_b32 v1, 4, v0
    v_add_u32 v1, 0, v1
    v_and_b32 v22, 7, v0
    v_xor_b32 v1, v1, v22
    v_lshrrev_b32 v22, 3, v0
    v_mul_u32_u24 v22, 1280, v22
    v_lshl_add_u32 v22, v1, 4, v22
    v_lshrrev_b32 v1, 4, v0
    v_add_u32 v1, 4, v1
    v_and_b32 v23, 7, v0
    v_xor_b32 v1, v1, v23
    v_lshrrev_b32 v23, 3, v0
    v_mul_u32_u24 v23, 1280, v23
    v_lshl_add_u32 v23, v1, 4, v23
    v_lshrrev_b32 v1, 4, v0
    v_add_u32 v1, 0, v1
    v_and_b32 v24, 7, v0
    v_xor_b32 v1, v1, v24
    v_lshrrev_b32 v24, 3, v0
    v_mul_u32_u24 v24, 3072, v24
    v_lshl_add_u32 v24, v1, 4, v24
    v_lshrrev_b32 v1, 4, v0
    v_add_u32 v1, 4, v1
    v_and_b32 v25, 7, v0
    v_xor_b32 v1, v1, v25
    v_lshrrev_b32 v25, 3, v0
    v_mul_u32_u24 v25, 3072, v25
    v_lshl_add_u32 v25, v1, 4, v25
    v_lshrrev_b32 v26, 3, v0
    v_mul_u32_u24 v26, 4096, v26
    v_bfe_u32 v1, v0, 4, 1
    v_lshlrev_b32 v1, 2, v1
    v_and_b32 v27, 7, v0
    v_xor_b32 v1, v1, v27
    v_lshl_add_u32 v26, v1, 4, v26
    v_mov_b32 v27, v26
    s_mul_i32 s46, s3, 3
    s_lshl_b32 s58, s46, 10
    s_cmp_ge_u32 s46, 10
    s_cbranch_scc1 pB_57
    s_mov_b32 s52, s16
    s_mov_b32 s53, s17
    s_mov_b32 s54, s18
    s_mov_b32 s55, s19
    s_mov_b32 s56, s36
    s_mov_b32 s57, 81920
    s_lshl_b32 s47, s46, 6
    v_add_u32 v1, s47, v0
    v_mul_u32_u24 v28, 6554, v1
    v_lshrrev_b32 v28, 16, v28
    v_mul_u32_u24 v4, 10, v28
    v_sub_u32 v1, v1, v4
    v_mul_u32_u24 v28, 1280, v28
    v_lshl_add_u32 v28, v1, 4, v28
    s_branch pt_58
pB_57:
    s_sub_u32 s48, s46, 10
    s_mov_b32 s52, s24
    s_mov_b32 s53, s25
    s_mov_b32 s54, s26
    s_mov_b32 s55, s27
    s_mul_i32 s47, s48, 10240
    s_add_u32 s56, s37, s47
    s_mov_b32 s57, 128
    s_bitcmp1_b32 s48, 0
    v_mov_b32 v28, v22
    s_cbranch_scc0 pt_58
    v_mov_b32 v28, v23
pt_58:
    s_mul_i32 s46, s3, 3
    s_add_u32 s46, s46, 1
    s_lshl_b32 s66, s46, 10
    s_cmp_ge_u32 s46, 10
    s_cbranch_scc1 pB_59
    s_mov_b32 s60, s16
    s_mov_b32 s61, s17
    s_mov_b32 s62, s18
    s_mov_b32 s63, s19
    s_mov_b32 s64, s36
    s_mov_b32 s65, 81920
    s_lshl_b32 s47, s46, 6
    v_add_u32 v1, s47, v0
    v_mul_u32_u24 v29, 6554, v1
    v_lshrrev_b32 v29, 16, v29
    v_mul_u32_u24 v4, 10, v29
    v_sub_u32 v1, v1, v4
    v_mul_u32_u24 v29, 1280, v29
    v_lshl_add_u32 v29, v1, 4, v29
    s_branch pt_60
pB_59:
    s_sub_u32 s48, s46, 10
    s_mov_b32 s60, s24
    s_mov_b32 s61, s25
    s_mov_b32 s62, s26
    s_mov_b32 s63, s27
    s_mul_i32 s47, s48, 10240
    s_add_u32 s64, s37, s47
    s_mov_b32 s65, 128
    s_bitcmp1_b32 s48, 0
    v_mov_b32 v29, v22
    s_cbranch_scc0 pt_60
    v_mov_b32 v29, v23
pt_60:
    s_mul_i32 s46, s3, 3
    s_add_u32 s46, s46, 2
    s_lshl_b32 s74, s46, 10
    s_cmp_ge_u32 s46, 10
    s_cbranch_scc1 pB_61
    s_mov_b32 s68, s16
    s_mov_b32 s69, s17
    s_mov_b32 s70, s18
    s_mov_b32 s71, s19
    s_mov_b32 s72, s36
    s_mov_b32 s73, 81920
    s_lshl_b32 s47, s46, 6
    v_add_u32 v1, s47, v0
    v_mul_u32_u24 v30, 6554, v1
    v_lshrrev_b32 v30, 16, v30
    v_mul_u32_u24 v4, 10, v30
    v_sub_u32 v1, v1, v4
    v_mul_u32_u24 v30, 1280, v30
    v_lshl_add_u32 v30, v1, 4, v30
    s_branch pt_62
pB_61:
    s_sub_u32 s48, s46, 10
    s_mov_b32 s68, s24
    s_mov_b32 s69, s25
    s_mov_b32 s70, s26
    s_mov_b32 s71, s27
    s_mul_i32 s47, s48, 10240
    s_add_u32 s72, s37, s47
    s_mov_b32 s73, 128
    s_bitcmp1_b32 s48, 0
    v_mov_b32 v30, v22
    s_cbranch_scc0 pt_62
    v_mov_b32 v30, v23
pt_62:
    s_mov_b32 s50, 0
    s_mov_b32 s51, 92160
    s_mov_b32 s100, 0
    s_mov_b32 s101, 0
    s_add_u32 s46, s58, s50
    s_mov_b32 m0, s46
    s_nop 0
    buffer_load_dwordx4 v28, s[52:55], s56 offen lds
    s_add_u32 s56, s56, s57
    s_add_u32 s46, s66, s50
    s_mov_b32 m0, s46
    s_nop 0
    buffer_load_dwordx4 v29, s[60:63], s64 offen lds
    s_add_u32 s64, s64, s65
    s_add_u32 s46, s74, s50
    s_mov_b32 m0, s46
    s_nop 0
    buffer_load_dwordx4 v30, s[68:71], s72 offen lds
    s_add_u32 s72, s72, s73
    s_add_u32 s50, s50, 18432
    s_cmp_eq_u32 s50, s51
    s_cselect_b32 s50, 0, s50
    s_add_u32 s46, s58, s50
    s_mov_b32 m0, s46
    s_nop 0
    buffer_load_dwordx4 v28, s[52:55], s56 offen lds
    s_add_u32 s56, s56, s57
    s_add_u32 s46, s66, s50
    s_mov_b32 m0, s46
    s_nop 0
    buffer_load_dwordx4 v29, s[60:63], s64 offen lds
    s_add_u32 s64, s64, s65
    s_add_u32 s46, s74, s50
    s_mov_b32 m0, s46
    s_nop 0
    buffer_load_dwordx4 v30, s[68:71], s72 offen lds
    s_add_u32 s72, s72, s73
    s_add_u32 s50, s50, 18432
    s_cmp_eq_u32 s50, s51
    s_cselect_b32 s50, 0, s50
    s_add_u32 s46, s58, s50
    s_mov_b32 m0, s46
    s_nop 0
    buffer_load_dwordx4 v28, s[52:55], s56 offen lds
    s_add_u32 s56, s56, s57
    s_add_u32 s46, s66, s50
    s_mov_b32 m0, s46
    s_nop 0
    buffer_load_dwordx4 v29, s[60:63], s64 offen lds
    s_add_u32 s64, s64, s65
    s_add_u32 s46, s74, s50
    s_mov_b32 m0, s46
    s_nop 0
    buffer_load_dwordx4 v30, s[68:71], s72 offen lds
    s_add_u32 s72, s72, s73
    s_add_u32 s50, s50, 18432
    s_cmp_eq_u32 s50, s51
    s_cselect_b32 s50, 0, s50
    s_add_u32 s46, s58, s50
    s_mov_b32 m0, s46
    s_nop 0
    buffer_load_dwordx4 v28, s[52:55], s56 offen lds
    s_add_u32 s56, s56, s57
    s_add_u32 s46, s66, s50
    s_mov_b32 m0, s46
    s_nop 0
    buffer_load_dwordx4 v29, s[60:63], s64 offen lds
    s_add_u32 s64, s64, s65
    s_add_u32 s46, s74, s50
    s_mov_b32 m0, s46
    s_nop 0
    buffer_load_dwordx4 v30, s[68:71], s72 offen lds
    s_add_u32 s72, s72, s73
    s_add_u32 s50, s50, 18432
    s_cmp_eq_u32 s50, s51
    s_cselect_b32 s50, 0, s50
    s_mul_i32 s46, s3, 3
    s_lshl_b32 s82, s46, 10
    s_cmp_ge_u32 s46, 10
    s_cbranch_scc1 pB_63
    s_mov_b32 s76, s24
    s_mov_b32 s77, s25
    s_mov_b32 s78, s26
    s_mov_b32 s79, s27
    s_mul_i32 s47, s46, 24576
    s_add_u32 s80, s39, s47
    s_mov_b32 s81, 128
    s_bitcmp1_b32 s46, 0
    v_mov_b32 v31, v24
    s_cbranch_scc0 pt_64
    v_mov_b32 v31, v25
    s_branch pt_64
pB_63:
    s_sub_u32 s48, s46, 10
    s_mov_b32 s76, s20
    s_mov_b32 s77, s21
    s_mov_b32 s78, s22
    s_mov_b32 s79, s23
    s_mul_i32 s47, s48, 32768
    s_add_u32 s80, s44, s47
    s_mov_b32 s81, 262144
    v_mov_b32 v31, v26
pt_64:
    s_mul_i32 s46, s3, 3
    s_add_u32 s46, s46, 1
    s_lshl_b32 s90, s46, 10
    s_cmp_ge_u32 s46, 10
    s_cbranch_scc1 pB_65
    s_mov_b32 s84, s24
    s_mov_b32 s85, s25
    s_mov_b32 s86, s26
    s_mov_b32 s87, s27
    s_mul_i32 s47, s46, 24576
    s_add_u32 s88, s39, s47
    s_mov_b32 s89, 128
    s_bitcmp1_b32 s46, 0
    v_mov_b32 v32, v24
    s_cbranch_scc0 pt_66
    v_mov_b32 v32, v25
    s_branch pt_66
pB_65:
    s_sub_u32 s48, s46, 10
    s_mov_b32 s84, s20
    s_mov_b32 s85, s21
    s_mov_b32 s86, s22
    s_mov_b32 s87, s23
    s_mul_i32 s47, s48, 32768
    s_add_u32 s88, s44, s47
    s_mov_b32 s89, 262144
    v_mov_b32 v32, v26
pt_66:
    s_mul_i32 s46, s3, 3
    s_add_u32 s46, s46, 2
    s_lshl_b32 s98, s46, 10
    s_cmp_ge_u32 s46, 10
    s_cbranch_scc1 pB_67
    s_mov_b32 s92, s24
    s_mov_b32 s93, s25
    s_mov_b32 s94, s26
    s_mov_b32 s95, s27
    s_mul_i32 s47, s46, 24576
    s_add_u32 s96, s39, s47
    s_mov_b32 s97, 128
    s_bitcmp1_b32 s46, 0
    v_mov_b32 v33, v24
    s_cbranch_scc0 pt_68
    v_mov_b32 v33, v25
    s_branch pt_68
pB_67:
    s_sub_u32 s48, s46, 10
    s_mov_b32 s92, s20
    s_mov_b32 s93, s21
    s_mov_b32 s94, s22
    s_mov_b32 s95, s23
    s_mul_i32 s47, s48, 32768
    s_add_u32 s96, s44, s47
    s_mov_b32 s97, 262144
    v_mov_b32 v33, v26
pt_68:
    v_bfe_u32 v34, v0, 5, 1
    v_lshlrev_b32 v34, 3, v34
    v_bfe_u32 v35, v0, 2, 2
    v_add_u32 v34, v34, v35
    v_mul_u32_u24 v34, 160, v34
    v_bfe_u32 v35, v0, 4, 1
    v_lshl_add_u32 v34, v35, 5, v34
    v_and_b32 v35, 3, v0
    v_lshl_add_u32 v34, v35, 3, v34
    s_lshl_b32 s46, s40, 6
    v_add_u32 v34, s46, v34
    s_lshl_b32 s48, s41, 12
    s_add_u32 s48, s48, 10240
    v_and_b32 v37, 31, v0
    v_lshrrev_b32 v38, 5, v0
    v_bfe_u32 v39, v0, 1, 3
    v_xor_b32 v38, v38, v39
    v_lshlrev_b32 v38, 4, v38
    v_lshl_add_u32 v36, v37, 7, v38
    v_add_u32 v36, s48, v36
    v_xor_b32 v37, 32, v36
    v_xor_b32 v38, 64, v36
    v_xor_b32 v39, 96, v36
    s_lshl_b32 s48, s40, 12
    v_and_b32 v113, 31, v0
    v_lshrrev_b32 v114, 5, v0
    v_bfe_u32 v115, v0, 1, 3
    v_xor_b32 v114, v114, v115
    v_lshlrev_b32 v114, 4, v114
    v_lshl_add_u32 v112, v113, 7, v114
    v_add_u32 v112, s48, v112
    v_xor_b32 v113, 32, v112
    v_xor_b32 v114, 64, v112
    v_xor_b32 v115, 96, v112
    s_lshl_b32 s48, s41, 12
    s_add_u32 s48, s48, 10240
    v_bfe_u32 v116, v0, 5, 1
    v_lshlrev_b32 v116, 3, v116
    v_bfe_u32 v117, v0, 2, 2
    v_add_u32 v116, v116, v117
    v_bfe_u32 v117, v0, 4, 1
    v_lshlrev_b32 v117, 1, v117
    v_bfe_u32 v118, v0, 1, 1
    v_add_u32 v117, v117, v118
    s_lshl_b32 s49, s41, 2
    v_add_u32 v117, s49, v117
    v_bfe_u32 v118, v116, 1, 1
    v_lshlrev_b32 v118, 2, v118
    v_xor_b32 v117, v117, v118
    v_lshlrev_b32 v116, 7, v116
    v_lshl_add_u32 v116, v117, 4, v116
    v_and_b32 v118, 1, v0
    v_lshl_add_u32 v116, v118, 3, v116
    v_add_u32 v116, 10240, v116
    s_lshl_b32 s48, s43, 6
    s_lshl_b32 s49, s41, 5
    s_add_u32 s48, s48, s49
    v_add_u32 v9, s48, v2
    v_lshlrev_b32 v12, 2, v9
    v_add_u32 v12, 2793472, v12
    buffer_load_dword v13, v12, s[24:27], 0 offen
    v_lshlrev_b32 v12, 1, v9
    buffer_load_ushort v14, v12, s[28:31], 0 offen
    v_mov_b32 v48, 0
    v_mov_b32 v49, 0
    v_mov_b32 v50, 0
    v_mov_b32 v51, 0
    v_mov_b32 v52, 0
    v_mov_b32 v53, 0
    v_mov_b32 v54, 0
    v_mov_b32 v55, 0
    v_mov_b32 v56, 0
    v_mov_b32 v57, 0
    v_mov_b32 v58, 0
    v_mov_b32 v59, 0
    v_mov_b32 v60, 0
    v_mov_b32 v61, 0
    v_mov_b32 v62, 0
    v_mov_b32 v63, 0
    v_mov_b32 v64, 0
    v_mov_b32 v65, 0
    v_mov_b32 v66, 0
    v_mov_b32 v67, 0
    v_mov_b32 v68, 0
    v_mov_b32 v69, 0
    v_mov_b32 v70, 0
    v_mov_b32 v71, 0
    v_mov_b32 v72, 0
    v_mov_b32 v73, 0
    v_mov_b32 v74, 0
    v_mov_b32 v75, 0
    v_mov_b32 v76, 0
    v_mov_b32 v77, 0
    v_mov_b32 v78, 0
    v_mov_b32 v79, 0
    s_waitcnt lgkmcnt(0)
    s_cmp_lt_u32 s101, 30
    s_cbranch_scc0 fn_69
    s_waitcnt vmcnt(9)
    s_barrier
    v_add_u32 v40, s100, v34
    v_add_u32 v41, s100, v36
    v_add_u32 v42, s100, v37
    v_add_u32 v43, s100, v38
    v_add_u32 v44, s100, v39
    ds_read_b64_tr_b16 v[80:81], v40 offset:0
    ds_read_b64_tr_b16 v[82:83], v40 offset:640
    ds_read_b128 v[84:87], v41 offset:0
    ds_read_b64_tr_b16 v[88:89], v40 offset:2560
    ds_read_b64_tr_b16 v[90:91], v40 offset:3200
    ds_read_b128 v[92:95], v42 offset:0
    ds_read_b64_tr_b16 v[96:97], v40 offset:5120
    ds_read_b64_tr_b16 v[98:99], v40 offset:5760
    ds_read_b128 v[100:103], v43 offset:0
    ds_read_b64_tr_b16 v[104:105], v40 offset:7680
    ds_read_b64_tr_b16 v[106:107], v40 offset:8320
    ds_read_b128 v[108:111], v44 offset:0
    s_add_u32 s100, s100, 18432
    s_cmp_eq_u32 s100, s51
    s_cselect_b32 s100, 0, s100
    s_cmp_eq_u32 s101, 6
    s_cbranch_scc0 fs_71
    s_mov_b32 s52, s76
    s_mov_b32 s53, s77
    s_mov_b32 s54, s78
    s_mov_b32 s55, s79
    s_mov_b32 s56, s80
    s_mov_b32 s57, s81
    s_mov_b32 s58, s82
    s_mov_b32 s59, s83
    s_mov_b32 s60, s84
    s_mov_b32 s61, s85
    s_mov_b32 s62, s86
    s_mov_b32 s63, s87
    s_mov_b32 s64, s88
    s_mov_b32 s65, s89
    s_mov_b32 s66, s90
    s_mov_b32 s67, s91
    s_mov_b32 s68, s92
    s_mov_b32 s69, s93
    s_mov_b32 s70, s94
    s_mov_b32 s71, s95
    s_mov_b32 s72, s96
    s_mov_b32 s73, s97
    s_mov_b32 s74, s98
    s_mov_b32 s75, s99
    v_mov_b32 v28, v31
    v_mov_b32 v29, v32
    v_mov_b32 v30, v33
fs_71:
    s_add_u32 s46, s58, s50
    s_mov_b32 m0, s46
    s_nop 0
    buffer_load_dwordx4 v28, s[52:55], s56 offen lds
    s_add_u32 s56, s56, s57
    s_add_u32 s46, s66, s50
    s_mov_b32 m0, s46
    s_nop 0
    buffer_load_dwordx4 v29, s[60:63], s64 offen lds
    s_add_u32 s64, s64, s65
    s_add_u32 s46, s74, s50
    s_mov_b32 m0, s46
    s_nop 0
    buffer_load_dwordx4 v30, s[68:71], s72 offen lds
    s_add_u32 s72, s72, s73
    s_add_u32 s50, s50, 18432
    s_cmp_eq_u32 s50, s51
    s_cselect_b32 s50, 0, s50
    s_branch fg_70
fn_69:
    s_waitcnt vmcnt(0)
    s_barrier
    v_add_u32 v40, s100, v34
    v_add_u32 v41, s100, v36
    v_add_u32 v42, s100, v37
    v_add_u32 v43, s100, v38
    v_add_u32 v44, s100, v39
    ds_read_b64_tr_b16 v[80:81], v40 offset:0
    ds_read_b64_tr_b16 v[82:83], v40 offset:640
    ds_read_b128 v[84:87], v41 offset:0
    ds_read_b64_tr_b16 v[88:89], v40 offset:2560
    ds_read_b64_tr_b16 v[90:91], v40 offset:3200
    ds_read_b128 v[92:95], v42 offset:0
    ds_read_b64_tr_b16 v[96:97], v40 offset:5120
    ds_read_b64_tr_b16 v[98:99], v40 offset:5760
    ds_read_b128 v[100:103], v43 offset:0
    ds_read_b64_tr_b16 v[104:105], v40 offset:7680
    ds_read_b64_tr_b16 v[106:107], v40 offset:8320
    ds_read_b128 v[108:111], v44 offset:0
    s_add_u32 s100, s100, 18432
    s_cmp_eq_u32 s100, s51
    s_cselect_b32 s100, 0, s100
fg_70:
    s_add_u32 s101, s101, 1
fl_72:
    s_waitcnt lgkmcnt(0)
    s_cmp_lt_u32 s101, 30
    s_cbranch_scc0 fn_73
    s_waitcnt vmcnt(9)
    s_barrier
    v_add_u32 v40, s100, v34
    v_add_u32 v41, s100, v36
    v_add_u32 v42, s100, v37
    v_add_u32 v43, s100, v38
    v_add_u32 v44, s100, v39
    v_mfma_f32_32x32x16_bf16 v[48:63], v[80:83], v[84:87], v[48:63]
    ds_read_b64_tr_b16 v[120:121], v40 offset:0
    ds_read_b64_tr_b16 v[122:123], v40 offset:640
    ds_read_b128 v[124:127], v41 offset:0
    v_mfma_f32_32x32x16_bf16 v[48:63], v[88:91], v[92:95], v[48:63]
    ds_read_b64_tr_b16 v[128:129], v40 offset:2560
    ds_read_b64_tr_b16 v[130:131], v40 offset:3200
    ds_read_b128 v[132:135], v42 offset:0
    v_mfma_f32_32x32x16_bf16 v[48:63], v[96:99], v[100:103], v[48:63]
    ds_read_b64_tr_b16 v[136:137], v40 offset:5120
    ds_read_b64_tr_b16 v[138:139], v40 offset:5760
    ds_read_b128 v[140:143], v43 offset:0
    v_mfma_f32_32x32x16_bf16 v[48:63], v[104:107], v[108:111], v[48:63]
    ds_read_b64_tr_b16 v[144:145], v40 offset:7680
    ds_read_b64_tr_b16 v[146:147], v40 offset:8320
    ds_read_b128 v[148:151], v44 offset:0
    s_add_u32 s100, s100, 18432
    s_cmp_eq_u32 s100, s51
    s_cselect_b32 s100, 0, s100
    s_cmp_eq_u32 s101, 6
    s_cbranch_scc0 fs_75
    s_mov_b32 s52, s76
    s_mov_b32 s53, s77
    s_mov_b32 s54, s78
    s_mov_b32 s55, s79
    s_mov_b32 s56, s80
    s_mov_b32 s57, s81
    s_mov_b32 s58, s82
    s_mov_b32 s59, s83
    s_mov_b32 s60, s84
    s_mov_b32 s61, s85
    s_mov_b32 s62, s86
    s_mov_b32 s63, s87
    s_mov_b32 s64, s88
    s_mov_b32 s65, s89
    s_mov_b32 s66, s90
    s_mov_b32 s67, s91
    s_mov_b32 s68, s92
    s_mov_b32 s69, s93
    s_mov_b32 s70, s94
    s_mov_b32 s71, s95
    s_mov_b32 s72, s96
    s_mov_b32 s73, s97
    s_mov_b32 s74, s98
    s_mov_b32 s75, s99
    v_mov_b32 v28, v31
    v_mov_b32 v29, v32
    v_mov_b32 v30, v33
fs_75:
    s_add_u32 s46, s58, s50
    s_mov_b32 m0, s46
    s_nop 0
    buffer_load_dwordx4 v28, s[52:55], s56 offen lds
    s_add_u32 s56, s56, s57
    s_add_u32 s46, s66, s50
    s_mov_b32 m0, s46
    s_nop 0
    buffer_load_dwordx4 v29, s[60:63], s64 offen lds
    s_add_u32 s64, s64, s65
    s_add_u32 s46, s74, s50
    s_mov_b32 m0, s46
    s_nop 0
    buffer_load_dwordx4 v30, s[68:71], s72 offen lds
    s_add_u32 s72, s72, s73
    s_add_u32 s50, s50, 18432
    s_cmp_eq_u32 s50, s51
    s_cselect_b32 s50, 0, s50
    s_branch fg_74
fn_73:
    s_waitcnt vmcnt(0)
    s_barrier
    v_add_u32 v40, s100, v34
    v_add_u32 v41, s100, v36
    v_add_u32 v42, s100, v37
    v_add_u32 v43, s100, v38
    v_add_u32 v44, s100, v39
    v_mfma_f32_32x32x16_bf16 v[48:63], v[80:83], v[84:87], v[48:63]
    ds_read_b64_tr_b16 v[120:121], v40 offset:0
    ds_read_b64_tr_b16 v[122:123], v40 offset:640
    ds_read_b128 v[124:127], v41 offset:0
    v_mfma_f32_32x32x16_bf16 v[48:63], v[88:91], v[92:95], v[48:63]
    ds_read_b64_tr_b16 v[128:129], v40 offset:2560
    ds_read_b64_tr_b16 v[130:131], v40 offset:3200
    ds_read_b128 v[132:135], v42 offset:0
    v_mfma_f32_32x32x16_bf16 v[48:63], v[96:99], v[100:103], v[48:63]
    ds_read_b64_tr_b16 v[136:137], v40 offset:5120
    ds_read_b64_tr_b16 v[138:139], v40 offset:5760
    ds_read_b128 v[140:143], v43 offset:0
    v_mfma_f32_32x32x16_bf16 v[48:63], v[104:107], v[108:111], v[48:63]
    ds_read_b64_tr_b16 v[144:145], v40 offset:7680
    ds_read_b64_tr_b16 v[146:147], v40 offset:8320
    ds_read_b128 v[148:151], v44 offset:0
    s_add_u32 s100, s100, 18432
    s_cmp_eq_u32 s100, s51
    s_cselect_b32 s100, 0, s100
fg_74:
    s_add_u32 s101, s101, 1
    s_waitcnt lgkmcnt(0)
    s_cmp_lt_u32 s101, 30
    s_cbranch_scc0 fn_76
    s_waitcnt vmcnt(9)
    s_barrier
    v_add_u32 v40, s100, v34
    v_add_u32 v41, s100, v36
    v_add_u32 v42, s100, v37
    v_add_u32 v43, s100, v38
    v_add_u32 v44, s100, v39
    v_mfma_f32_32x32x16_bf16 v[48:63], v[120:123], v[124:127], v[48:63]
    ds_read_b64_tr_b16 v[80:81], v40 offset:0
    ds_read_b64_tr_b16 v[82:83], v40 offset:640
    ds_read_b128 v[84:87], v41 offset:0
    v_mfma_f32_32x32x16_bf16 v[48:63], v[128:131], v[132:135], v[48:63]
    ds_read_b64_tr_b16 v[88:89], v40 offset:2560
    ds_read_b64_tr_b16 v[90:91], v40 offset:3200
    ds_read_b128 v[92:95], v42 offset:0
    v_mfma_f32_32x32x16_bf16 v[48:63], v[136:139], v[140:143], v[48:63]
    ds_read_b64_tr_b16 v[96:97], v40 offset:5120
    ds_read_b64_tr_b16 v[98:99], v40 offset:5760
    ds_read_b128 v[100:103], v43 offset:0
    v_mfma_f32_32x32x16_bf16 v[48:63], v[144:147], v[148:151], v[48:63]
    ds_read_b64_tr_b16 v[104:105], v40 offset:7680
    ds_read_b64_tr_b16 v[106:107], v40 offset:8320
    ds_read_b128 v[108:111], v44 offset:0
    s_add_u32 s100, s100, 18432
    s_cmp_eq_u32 s100, s51
    s_cselect_b32 s100, 0, s100
    s_cmp_eq_u32 s101, 6
    s_cbranch_scc0 fs_78
    s_mov_b32 s52, s76
    s_mov_b32 s53, s77
    s_mov_b32 s54, s78
    s_mov_b32 s55, s79
    s_mov_b32 s56, s80
    s_mov_b32 s57, s81
    s_mov_b32 s58, s82
    s_mov_b32 s59, s83
    s_mov_b32 s60, s84
    s_mov_b32 s61, s85
    s_mov_b32 s62, s86
    s_mov_b32 s63, s87
    s_mov_b32 s64, s88
    s_mov_b32 s65, s89
    s_mov_b32 s66, s90
    s_mov_b32 s67, s91
    s_mov_b32 s68, s92
    s_mov_b32 s69, s93
    s_mov_b32 s70, s94
    s_mov_b32 s71, s95
    s_mov_b32 s72, s96
    s_mov_b32 s73, s97
    s_mov_b32 s74, s98
    s_mov_b32 s75, s99
    v_mov_b32 v28, v31
    v_mov_b32 v29, v32
    v_mov_b32 v30, v33
fs_78:
    s_add_u32 s46, s58, s50
    s_mov_b32 m0, s46
    s_nop 0
    buffer_load_dwordx4 v28, s[52:55], s56 offen lds
    s_add_u32 s56, s56, s57
    s_add_u32 s46, s66, s50
    s_mov_b32 m0, s46
    s_nop 0
    buffer_load_dwordx4 v29, s[60:63], s64 offen lds
    s_add_u32 s64, s64, s65
    s_add_u32 s46, s74, s50
    s_mov_b32 m0, s46
    s_nop 0
    buffer_load_dwordx4 v30, s[68:71], s72 offen lds
    s_add_u32 s72, s72, s73
    s_add_u32 s50, s50, 18432
    s_cmp_eq_u32 s50, s51
    s_cselect_b32 s50, 0, s50
    s_branch fg_77
fn_76:
    s_waitcnt vmcnt(0)
    s_barrier
    v_add_u32 v40, s100, v34
    v_add_u32 v41, s100, v36
    v_add_u32 v42, s100, v37
    v_add_u32 v43, s100, v38
    v_add_u32 v44, s100, v39
    v_mfma_f32_32x32x16_bf16 v[48:63], v[120:123], v[124:127], v[48:63]
    ds_read_b64_tr_b16 v[80:81], v40 offset:0
    ds_read_b64_tr_b16 v[82:83], v40 offset:640
    ds_read_b128 v[84:87], v41 offset:0
    v_mfma_f32_32x32x16_bf16 v[48:63], v[128:131], v[132:135], v[48:63]
    ds_read_b64_tr_b16 v[88:89], v40 offset:2560
    ds_read_b64_tr_b16 v[90:91], v40 offset:3200
    ds_read_b128 v[92:95], v42 offset:0
    v_mfma_f32_32x32x16_bf16 v[48:63], v[136:139], v[140:143], v[48:63]
    ds_read_b64_tr_b16 v[96:97], v40 offset:5120
    ds_read_b64_tr_b16 v[98:99], v40 offset:5760
    ds_read_b128 v[100:103], v43 offset:0
    v_mfma_f32_32x32x16_bf16 v[48:63], v[144:147], v[148:151], v[48:63]
    ds_read_b64_tr_b16 v[104:105], v40 offset:7680
    ds_read_b64_tr_b16 v[106:107], v40 offset:8320
    ds_read_b128 v[108:111], v44 offset:0
    s_add_u32 s100, s100, 18432
    s_cmp_eq_u32 s100, s51
    s_cselect_b32 s100, 0, s100
fg_77:
    s_add_u32 s101, s101, 1
    s_cmp_lt_u32 s101, 9
    s_cbranch_scc1 fl_72
    s_waitcnt lgkmcnt(0)
    s_cmp_lt_u32 s101, 30
    s_cbranch_scc0 fn_79
    s_waitcnt vmcnt(9)
    s_barrier
    v_add_u32 v40, s100, v34
    v_add_u32 v41, s100, v36
    v_add_u32 v42, s100, v37
    v_add_u32 v43, s100, v38
    v_add_u32 v44, s100, v39
    v_mfma_f32_32x32x16_bf16 v[48:63], v[80:83], v[84:87], v[48:63]
    ds_read_b64_tr_b16 v[120:121], v40 offset:0
    ds_read_b64_tr_b16 v[122:123], v40 offset:640
    ds_read_b128 v[124:127], v41 offset:0
    v_mfma_f32_32x32x16_bf16 v[48:63], v[88:91], v[92:95], v[48:63]
    ds_read_b64_tr_b16 v[128:129], v40 offset:2560
    ds_read_b64_tr_b16 v[130:131], v40 offset:3200
    ds_read_b128 v[132:135], v42 offset:0
    v_mfma_f32_32x32x16_bf16 v[48:63], v[96:99], v[100:103], v[48:63]
    ds_read_b64_tr_b16 v[136:137], v40 offset:5120
    ds_read_b64_tr_b16 v[138:139], v40 offset:5760
    ds_read_b128 v[140:143], v43 offset:0
    v_mfma_f32_32x32x16_bf16 v[48:63], v[104:107], v[108:111], v[48:63]
    ds_read_b64_tr_b16 v[144:145], v40 offset:7680
    ds_read_b64_tr_b16 v[146:147], v40 offset:8320
    ds_read_b128 v[148:151], v44 offset:0
    s_add_u32 s100, s100, 18432
    s_cmp_eq_u32 s100, s51
    s_cselect_b32 s100, 0, s100
    s_cmp_eq_u32 s101, 6
    s_cbranch_scc0 fs_81
    s_mov_b32 s52, s76
    s_mov_b32 s53, s77
    s_mov_b32 s54, s78
    s_mov_b32 s55, s79
    s_mov_b32 s56, s80
    s_mov_b32 s57, s81
    s_mov_b32 s58, s82
    s_mov_b32 s59, s83
    s_mov_b32 s60, s84
    s_mov_b32 s61, s85
    s_mov_b32 s62, s86
    s_mov_b32 s63, s87
    s_mov_b32 s64, s88
    s_mov_b32 s65, s89
    s_mov_b32 s66, s90
    s_mov_b32 s67, s91
    s_mov_b32 s68, s92
    s_mov_b32 s69, s93
    s_mov_b32 s70, s94
    s_mov_b32 s71, s95
    s_mov_b32 s72, s96
    s_mov_b32 s73, s97
    s_mov_b32 s74, s98
    s_mov_b32 s75, s99
    v_mov_b32 v28, v31
    v_mov_b32 v29, v32
    v_mov_b32 v30, v33
fs_81:
    s_add_u32 s46, s58, s50
    s_mov_b32 m0, s46
    s_nop 0
    buffer_load_dwordx4 v28, s[52:55], s56 offen lds
    s_add_u32 s56, s56, s57
    s_add_u32 s46, s66, s50
    s_mov_b32 m0, s46
    s_nop 0
    buffer_load_dwordx4 v29, s[60:63], s64 offen lds
    s_add_u32 s64, s64, s65
    s_add_u32 s46, s74, s50
    s_mov_b32 m0, s46
    s_nop 0
    buffer_load_dwordx4 v30, s[68:71], s72 offen lds
    s_add_u32 s72, s72, s73
    s_add_u32 s50, s50, 18432
    s_cmp_eq_u32 s50, s51
    s_cselect_b32 s50, 0, s50
    s_branch fg_80
fn_79:
    s_waitcnt vmcnt(0)
    s_barrier
    v_add_u32 v40, s100, v34
    v_add_u32 v41, s100, v36
    v_add_u32 v42, s100, v37
    v_add_u32 v43, s100, v38
    v_add_u32 v44, s100, v39
    v_mfma_f32_32x32x16_bf16 v[48:63], v[80:83], v[84:87], v[48:63]
    ds_read_b64_tr_b16 v[120:121], v40 offset:0
    ds_read_b64_tr_b16 v[122:123], v40 offset:640
    ds_read_b128 v[124:127], v41 offset:0
    v_mfma_f32_32x32x16_bf16 v[48:63], v[88:91], v[92:95], v[48:63]
    ds_read_b64_tr_b16 v[128:129], v40 offset:2560
    ds_read_b64_tr_b16 v[130:131], v40 offset:3200
    ds_read_b128 v[132:135], v42 offset:0
    v_mfma_f32_32x32x16_bf16 v[48:63], v[96:99], v[100:103], v[48:63]
    ds_read_b64_tr_b16 v[136:137], v40 offset:5120
    ds_read_b64_tr_b16 v[138:139], v40 offset:5760
    ds_read_b128 v[140:143], v43 offset:0
    v_mfma_f32_32x32x16_bf16 v[48:63], v[104:107], v[108:111], v[48:63]
    ds_read_b64_tr_b16 v[144:145], v40 offset:7680
    ds_read_b64_tr_b16 v[146:147], v40 offset:8320
    ds_read_b128 v[148:151], v44 offset:0
    s_add_u32 s100, s100, 18432
    s_cmp_eq_u32 s100, s51
    s_cselect_b32 s100, 0, s100
fg_80:
    s_add_u32 s101, s101, 1
    s_waitcnt lgkmcnt(0)
    s_cmp_lt_u32 s101, 30
    s_cbranch_scc0 fn_82
    s_waitcnt vmcnt(9)
    s_barrier
    v_add_u32 v40, s100, v112
    v_add_u32 v41, s100, v113
    v_add_u32 v42, s100, v114
    v_add_u32 v43, s100, v115
    v_add_u32 v44, s100, v116
    v_mfma_f32_32x32x16_bf16 v[48:63], v[120:123], v[124:127], v[48:63]
    ds_read_b128 v[80:83], v40 offset:0
    ds_read_b64_tr_b16 v[84:85], v44 offset:0
    ds_read_b64_tr_b16 v[86:87], v44 offset:512
    v_mfma_f32_32x32x16_bf16 v[48:63], v[128:131], v[132:135], v[48:63]
    ds_read_b128 v[88:91], v41 offset:0
    ds_read_b64_tr_b16 v[92:93], v44 offset:2048
    ds_read_b64_tr_b16 v[94:95], v44 offset:2560
    v_mfma_f32_32x32x16_bf16 v[48:63], v[136:139], v[140:143], v[48:63]
    ds_read_b128 v[96:99], v42 offset:0
    ds_read_b64_tr_b16 v[100:101], v44 offset:4096
    ds_read_b64_tr_b16 v[102:103], v44 offset:4608
    v_mfma_f32_32x32x16_bf16 v[48:63], v[144:147], v[148:151], v[48:63]
    ds_read_b128 v[104:107], v43 offset:0
    ds_read_b64_tr_b16 v[108:109], v44 offset:6144
    ds_read_b64_tr_b16 v[110:111], v44 offset:6656
    s_add_u32 s100, s100, 18432
    s_cmp_eq_u32 s100, s51
    s_cselect_b32 s100, 0, s100
    s_add_u32 s46, s58, s50
    s_mov_b32 m0, s46
    s_nop 0
    buffer_load_dwordx4 v28, s[52:55], s56 offen lds
    s_add_u32 s56, s56, s57
    s_add_u32 s46, s66, s50
    s_mov_b32 m0, s46
    s_nop 0
    buffer_load_dwordx4 v29, s[60:63], s64 offen lds
    s_add_u32 s64, s64, s65
    s_add_u32 s46, s74, s50
    s_mov_b32 m0, s46
    s_nop 0
    buffer_load_dwordx4 v30, s[68:71], s72 offen lds
    s_add_u32 s72, s72, s73
    s_add_u32 s50, s50, 18432
    s_cmp_eq_u32 s50, s51
    s_cselect_b32 s50, 0, s50
    s_branch fg_83
fn_82:
    s_waitcnt vmcnt(0)
    s_barrier
    v_add_u32 v40, s100, v112
    v_add_u32 v41, s100, v113
    v_add_u32 v42, s100, v114
    v_add_u32 v43, s100, v115
    v_add_u32 v44, s100, v116
    v_mfma_f32_32x32x16_bf16 v[48:63], v[120:123], v[124:127], v[48:63]
    ds_read_b128 v[80:83], v40 offset:0
    ds_read_b64_tr_b16 v[84:85], v44 offset:0
    ds_read_b64_tr_b16 v[86:87], v44 offset:512
    v_mfma_f32_32x32x16_bf16 v[48:63], v[128:131], v[132:135], v[48:63]
    ds_read_b128 v[88:91], v41 offset:0
    ds_read_b64_tr_b16 v[92:93], v44 offset:2048
    ds_read_b64_tr_b16 v[94:95], v44 offset:2560
    v_mfma_f32_32x32x16_bf16 v[48:63], v[136:139], v[140:143], v[48:63]
    ds_read_b128 v[96:99], v42 offset:0
    ds_read_b64_tr_b16 v[100:101], v44 offset:4096
    ds_read_b64_tr_b16 v[102:103], v44 offset:4608
    v_mfma_f32_32x32x16_bf16 v[48:63], v[144:147], v[148:151], v[48:63]
    ds_read_b128 v[104:107], v43 offset:0
    ds_read_b64_tr_b16 v[108:109], v44 offset:6144
    ds_read_b64_tr_b16 v[110:111], v44 offset:6656
    s_add_u32 s100, s100, 18432
    s_cmp_eq_u32 s100, s51
    s_cselect_b32 s100, 0, s100
fg_83:
    s_add_u32 s101, s101, 1
fl_85:
    s_waitcnt lgkmcnt(0)
    s_cmp_lt_u32 s101, 30
    s_cbranch_scc0 fn_86
    s_waitcnt vmcnt(9)
    s_barrier
    v_add_u32 v40, s100, v112
    v_add_u32 v41, s100, v113
    v_add_u32 v42, s100, v114
    v_add_u32 v43, s100, v115
    v_add_u32 v44, s100, v116
    v_mfma_f32_32x32x16_bf16 v[64:79], v[80:83], v[84:87], v[64:79]
    ds_read_b128 v[120:123], v40 offset:0
    ds_read_b64_tr_b16 v[124:125], v44 offset:0
    ds_read_b64_tr_b16 v[126:127], v44 offset:512
    v_mfma_f32_32x32x16_bf16 v[64:79], v[88:91], v[92:95], v[64:79]
    ds_read_b128 v[128:131], v41 offset:0
    ds_read_b64_tr_b16 v[132:133], v44 offset:2048
    ds_read_b64_tr_b16 v[134:135], v44 offset:2560
    v_mfma_f32_32x32x16_bf16 v[64:79], v[96:99], v[100:103], v[64:79]
    ds_read_b128 v[136:139], v42 offset:0
    ds_read_b64_tr_b16 v[140:141], v44 offset:4096
    ds_read_b64_tr_b16 v[142:143], v44 offset:4608
    v_mfma_f32_32x32x16_bf16 v[64:79], v[104:107], v[108:111], v[64:79]
    ds_read_b128 v[144:147], v43 offset:0
    ds_read_b64_tr_b16 v[148:149], v44 offset:6144
    ds_read_b64_tr_b16 v[150:151], v44 offset:6656
    s_add_u32 s100, s100, 18432
    s_cmp_eq_u32 s100, s51
    s_cselect_b32 s100, 0, s100
    s_add_u32 s46, s58, s50
    s_mov_b32 m0, s46
    s_nop 0
    buffer_load_dwordx4 v28, s[52:55], s56 offen lds
    s_add_u32 s56, s56, s57
    s_add_u32 s46, s66, s50
    s_mov_b32 m0, s46
    s_nop 0
    buffer_load_dwordx4 v29, s[60:63], s64 offen lds
    s_add_u32 s64, s64, s65
    s_add_u32 s46, s74, s50
    s_mov_b32 m0, s46
    s_nop 0
    buffer_load_dwordx4 v30, s[68:71], s72 offen lds
    s_add_u32 s72, s72, s73
    s_add_u32 s50, s50, 18432
    s_cmp_eq_u32 s50, s51
    s_cselect_b32 s50, 0, s50
    s_branch fg_87
fn_86:
    s_waitcnt vmcnt(0)
    s_barrier
    v_add_u32 v40, s100, v112
    v_add_u32 v41, s100, v113
    v_add_u32 v42, s100, v114
    v_add_u32 v43, s100, v115
    v_add_u32 v44, s100, v116
    v_mfma_f32_32x32x16_bf16 v[64:79], v[80:83], v[84:87], v[64:79]
    ds_read_b128 v[120:123], v40 offset:0
    ds_read_b64_tr_b16 v[124:125], v44 offset:0
    ds_read_b64_tr_b16 v[126:127], v44 offset:512
    v_mfma_f32_32x32x16_bf16 v[64:79], v[88:91], v[92:95], v[64:79]
    ds_read_b128 v[128:131], v41 offset:0
    ds_read_b64_tr_b16 v[132:133], v44 offset:2048
    ds_read_b64_tr_b16 v[134:135], v44 offset:2560
    v_mfma_f32_32x32x16_bf16 v[64:79], v[96:99], v[100:103], v[64:79]
    ds_read_b128 v[136:139], v42 offset:0
    ds_read_b64_tr_b16 v[140:141], v44 offset:4096
    ds_read_b64_tr_b16 v[142:143], v44 offset:4608
    v_mfma_f32_32x32x16_bf16 v[64:79], v[104:107], v[108:111], v[64:79]
    ds_read_b128 v[144:147], v43 offset:0
    ds_read_b64_tr_b16 v[148:149], v44 offset:6144
    ds_read_b64_tr_b16 v[150:151], v44 offset:6656
    s_add_u32 s100, s100, 18432
    s_cmp_eq_u32 s100, s51
    s_cselect_b32 s100, 0, s100
fg_87:
    s_add_u32 s101, s101, 1
    s_waitcnt lgkmcnt(0)
    s_cmp_lt_u32 s101, 30
    s_cbranch_scc0 fn_89
    s_waitcnt vmcnt(9)
    s_barrier
    v_add_u32 v40, s100, v112
    v_add_u32 v41, s100, v113
    v_add_u32 v42, s100, v114
    v_add_u32 v43, s100, v115
    v_add_u32 v44, s100, v116
    v_mfma_f32_32x32x16_bf16 v[64:79], v[120:123], v[124:127], v[64:79]
    ds_read_b128 v[80:83], v40 offset:0
    ds_read_b64_tr_b16 v[84:85], v44 offset:0
    ds_read_b64_tr_b16 v[86:87], v44 offset:512
    v_mfma_f32_32x32x16_bf16 v[64:79], v[128:131], v[132:135], v[64:79]
    ds_read_b128 v[88:91], v41 offset:0
    ds_read_b64_tr_b16 v[92:93], v44 offset:2048
    ds_read_b64_tr_b16 v[94:95], v44 offset:2560
    v_mfma_f32_32x32x16_bf16 v[64:79], v[136:139], v[140:143], v[64:79]
    ds_read_b128 v[96:99], v42 offset:0
    ds_read_b64_tr_b16 v[100:101], v44 offset:4096
    ds_read_b64_tr_b16 v[102:103], v44 offset:4608
    v_mfma_f32_32x32x16_bf16 v[64:79], v[144:147], v[148:151], v[64:79]
    ds_read_b128 v[104:107], v43 offset:0
    ds_read_b64_tr_b16 v[108:109], v44 offset:6144
    ds_read_b64_tr_b16 v[110:111], v44 offset:6656
    s_add_u32 s100, s100, 18432
    s_cmp_eq_u32 s100, s51
    s_cselect_b32 s100, 0, s100
    s_add_u32 s46, s58, s50
    s_mov_b32 m0, s46
    s_nop 0
    buffer_load_dwordx4 v28, s[52:55], s56 offen lds
    s_add_u32 s56, s56, s57
    s_add_u32 s46, s66, s50
    s_mov_b32 m0, s46
    s_nop 0
    buffer_load_dwordx4 v29, s[60:63], s64 offen lds
    s_add_u32 s64, s64, s65
    s_add_u32 s46, s74, s50
    s_mov_b32 m0, s46
    s_nop 0
    buffer_load_dwordx4 v30, s[68:71], s72 offen lds
    s_add_u32 s72, s72, s73
    s_add_u32 s50, s50, 18432
    s_cmp_eq_u32 s50, s51
    s_cselect_b32 s50, 0, s50
    s_branch fg_90
fn_89:
    s_waitcnt vmcnt(0)
    s_barrier
    v_add_u32 v40, s100, v112
    v_add_u32 v41, s100, v113
    v_add_u32 v42, s100, v114
    v_add_u32 v43, s100, v115
    v_add_u32 v44, s100, v116
    v_mfma_f32_32x32x16_bf16 v[64:79], v[120:123], v[124:127], v[64:79]
    ds_read_b128 v[80:83], v40 offset:0
    ds_read_b64_tr_b16 v[84:85], v44 offset:0
    ds_read_b64_tr_b16 v[86:87], v44 offset:512
    v_mfma_f32_32x32x16_bf16 v[64:79], v[128:131], v[132:135], v[64:79]
    ds_read_b128 v[88:91], v41 offset:0
    ds_read_b64_tr_b16 v[92:93], v44 offset:2048
    ds_read_b64_tr_b16 v[94:95], v44 offset:2560
    v_mfma_f32_32x32x16_bf16 v[64:79], v[136:139], v[140:143], v[64:79]
    ds_read_b128 v[96:99], v42 offset:0
    ds_read_b64_tr_b16 v[100:101], v44 offset:4096
    ds_read_b64_tr_b16 v[102:103], v44 offset:4608
    v_mfma_f32_32x32x16_bf16 v[64:79], v[144:147], v[148:151], v[64:79]
    ds_read_b128 v[104:107], v43 offset:0
    ds_read_b64_tr_b16 v[108:109], v44 offset:6144
    ds_read_b64_tr_b16 v[110:111], v44 offset:6656
    s_add_u32 s100, s100, 18432
    s_cmp_eq_u32 s100, s51
    s_cselect_b32 s100, 0, s100
fg_90:
    s_add_u32 s101, s101, 1
    s_cmp_lt_u32 s101, 33
    s_cbranch_scc1 fl_85
    s_waitcnt lgkmcnt(0)
    s_cmp_lt_u32 s101, 30
    s_cbranch_scc0 fn_92
    s_waitcnt vmcnt(9)
    s_barrier
    v_add_u32 v40, s100, v112
    v_add_u32 v41, s100, v113
    v_add_u32 v42, s100, v114
    v_add_u32 v43, s100, v115
    v_add_u32 v44, s100, v116
    v_mfma_f32_32x32x16_bf16 v[64:79], v[80:83], v[84:87], v[64:79]
    ds_read_b128 v[120:123], v40 offset:0
    ds_read_b64_tr_b16 v[124:125], v44 offset:0
    ds_read_b64_tr_b16 v[126:127], v44 offset:512
    v_mfma_f32_32x32x16_bf16 v[64:79], v[88:91], v[92:95], v[64:79]
    ds_read_b128 v[128:131], v41 offset:0
    ds_read_b64_tr_b16 v[132:133], v44 offset:2048
    ds_read_b64_tr_b16 v[134:135], v44 offset:2560
    v_mfma_f32_32x32x16_bf16 v[64:79], v[96:99], v[100:103], v[64:79]
    ds_read_b128 v[136:139], v42 offset:0
    ds_read_b64_tr_b16 v[140:141], v44 offset:4096
    ds_read_b64_tr_b16 v[142:143], v44 offset:4608
    v_mfma_f32_32x32x16_bf16 v[64:79], v[104:107], v[108:111], v[64:79]
    ds_read_b128 v[144:147], v43 offset:0
    ds_read_b64_tr_b16 v[148:149], v44 offset:6144
    ds_read_b64_tr_b16 v[150:151], v44 offset:6656
    s_add_u32 s100, s100, 18432
    s_cmp_eq_u32 s100, s51
    s_cselect_b32 s100, 0, s100
    s_add_u32 s46, s58, s50
    s_mov_b32 m0, s46
    s_nop 0
    buffer_load_dwordx4 v28, s[52:55], s56 offen lds
    s_add_u32 s56, s56, s57
    s_add_u32 s46, s66, s50
    s_mov_b32 m0, s46
    s_nop 0
    buffer_load_dwordx4 v29, s[60:63], s64 offen lds
    s_add_u32 s64, s64, s65
    s_add_u32 s46, s74, s50
    s_mov_b32 m0, s46
    s_nop 0
    buffer_load_dwordx4 v30, s[68:71], s72 offen lds
    s_add_u32 s72, s72, s73
    s_add_u32 s50, s50, 18432
    s_cmp_eq_u32 s50, s51
    s_cselect_b32 s50, 0, s50
    s_branch fg_93
fn_92:
    s_waitcnt vmcnt(0)
    s_barrier
    v_add_u32 v40, s100, v112
    v_add_u32 v41, s100, v113
    v_add_u32 v42, s100, v114
    v_add_u32 v43, s100, v115
    v_add_u32 v44, s100, v116
    v_mfma_f32_32x32x16_bf16 v[64:79], v[80:83], v[84:87], v[64:79]
    ds_read_b128 v[120:123], v40 offset:0
    ds_read_b64_tr_b16 v[124:125], v44 offset:0
    ds_read_b64_tr_b16 v[126:127], v44 offset:512
    v_mfma_f32_32x32x16_bf16 v[64:79], v[88:91], v[92:95], v[64:79]
    ds_read_b128 v[128:131], v41 offset:0
    ds_read_b64_tr_b16 v[132:133], v44 offset:2048
    ds_read_b64_tr_b16 v[134:135], v44 offset:2560
    v_mfma_f32_32x32x16_bf16 v[64:79], v[96:99], v[100:103], v[64:79]
    ds_read_b128 v[136:139], v42 offset:0
    ds_read_b64_tr_b16 v[140:141], v44 offset:4096
    ds_read_b64_tr_b16 v[142:143], v44 offset:4608
    v_mfma_f32_32x32x16_bf16 v[64:79], v[104:107], v[108:111], v[64:79]
    ds_read_b128 v[144:147], v43 offset:0
    ds_read_b64_tr_b16 v[148:149], v44 offset:6144
    ds_read_b64_tr_b16 v[150:151], v44 offset:6656
    s_add_u32 s100, s100, 18432
    s_cmp_eq_u32 s100, s51
    s_cselect_b32 s100, 0, s100
fg_93:
    s_add_u32 s101, s101, 1
    s_waitcnt lgkmcnt(0)
    v_mfma_f32_32x32x16_bf16 v[64:79], v[120:123], v[124:127], v[64:79]
    v_mfma_f32_32x32x16_bf16 v[64:79], v[128:131], v[132:135], v[64:79]
    v_mfma_f32_32x32x16_bf16 v[64:79], v[136:139], v[140:143], v[64:79]
    v_mfma_f32_32x32x16_bf16 v[64:79], v[144:147], v[148:151], v[64:79]
    s_nop 15
    v_lshlrev_b32 v14, 16, v14
    v_sub_f32 v18, 1.0, v13
    v_add_f32 v64, v64, v14
    v_mul_f32 v64, v64, v18
    v_fmac_f32 v64, v48, v13
    v_add_f32 v65, v65, v14
    v_mul_f32 v65, v65, v18
    v_fmac_f32 v65, v49, v13
    v_add_f32 v66, v66, v14
    v_mul_f32 v66, v66, v18
    v_fmac_f32 v66, v50, v13
    v_add_f32 v67, v67, v14
    v_mul_f32 v67, v67, v18
    v_fmac_f32 v67, v51, v13
    v_add_f32 v68, v68, v14
    v_mul_f32 v68, v68, v18
    v_fmac_f32 v68, v52, v13
    v_add_f32 v69, v69, v14
    v_mul_f32 v69, v69, v18
    v_fmac_f32 v69, v53, v13
    v_add_f32 v70, v70, v14
    v_mul_f32 v70, v70, v18
    v_fmac_f32 v70, v54, v13
    v_add_f32 v71, v71, v14
    v_mul_f32 v71, v71, v18
    v_fmac_f32 v71, v55, v13
    v_add_f32 v72, v72, v14
    v_mul_f32 v72, v72, v18
    v_fmac_f32 v72, v56, v13
    v_add_f32 v73, v73, v14
    v_mul_f32 v73, v73, v18
    v_fmac_f32 v73, v57, v13
    v_add_f32 v74, v74, v14
    v_mul_f32 v74, v74, v18
    v_fmac_f32 v74, v58, v13
    v_add_f32 v75, v75, v14
    v_mul_f32 v75, v75, v18
    v_fmac_f32 v75, v59, v13
    v_add_f32 v76, v76, v14
    v_mul_f32 v76, v76, v18
    v_fmac_f32 v76, v60, v13
    v_add_f32 v77, v77, v14
    v_mul_f32 v77, v77, v18
    v_fmac_f32 v77, v61, v13
    v_add_f32 v78, v78, v14
    v_mul_f32 v78, v78, v18
    v_fmac_f32 v78, v62, v13
    v_add_f32 v79, v79, v14
    v_mul_f32 v79, v79, v18
    v_fmac_f32 v79, v63, v13
    v_mul_u32_u24 v19, 1280, v9
    v_lshl_add_u32 v19, v3, 3, v19
    s_lshl_b32 s50, s40, 6
    s_add_u32 s50, s50, s36
    v_cvt_pk_bf16_f32 v80, v64, v65
    v_cvt_pk_bf16_f32 v81, v66, v67
    v_cvt_pk_bf16_f32 v82, v68, v69
    v_cvt_pk_bf16_f32 v83, v70, v71
    v_cvt_pk_bf16_f32 v84, v72, v73
    v_cvt_pk_bf16_f32 v85, v74, v75
    v_cvt_pk_bf16_f32 v86, v76, v77
    v_cvt_pk_bf16_f32 v87, v78, v79
    buffer_store_dwordx2 v[80:81], v19, s[32:35], s50 offen offset:0
    buffer_store_dwordx2 v[82:83], v19, s[32:35], s50 offen offset:16
    s_cmp_eq_u32 s40, 2
    s_cbranch_scc1 F_exit
    buffer_store_dwordx2 v[84:85], v19, s[32:35], s50 offen offset:32
    buffer_store_dwordx2 v[86:87], v19, s[32:35], s50 offen offset:48
F_exit:
    s_endpgm
.section .rodata,"a"
.p2align 6
.amdhsa_kernel prep_kernel
  .amdhsa_next_free_vgpr 144
  .amdhsa_next_free_sgpr 102
  .amdhsa_accum_offset 144
  .amdhsa_group_segment_fixed_size 0
  .amdhsa_kernarg_size 112
  .amdhsa_user_sgpr_count 2
  .amdhsa_user_sgpr_kernarg_segment_ptr 1
  .amdhsa_system_sgpr_workgroup_id_x 1
.end_amdhsa_kernel
.p2align 6
.amdhsa_kernel mid_kernel
  .amdhsa_next_free_vgpr 128
  .amdhsa_next_free_sgpr 102
  .amdhsa_accum_offset 128
  .amdhsa_group_segment_fixed_size 0
  .amdhsa_kernarg_size 112
  .amdhsa_user_sgpr_count 2
  .amdhsa_user_sgpr_kernarg_segment_ptr 1
  .amdhsa_system_sgpr_workgroup_id_x 1
.end_amdhsa_kernel
.p2align 6
.amdhsa_kernel final_kernel
  .amdhsa_next_free_vgpr 152
  .amdhsa_next_free_sgpr 102
  .amdhsa_accum_offset 152
  .amdhsa_group_segment_fixed_size 0
  .amdhsa_kernarg_size 112
  .amdhsa_user_sgpr_count 2
  .amdhsa_user_sgpr_kernarg_segment_ptr 1
  .amdhsa_system_sgpr_workgroup_id_x 1
.end_amdhsa_kernel
```
